```python
import torch

def _softmax(x, axis=-1):
    return torch.softmax(x, dim=axis)
def _gelu(x):
    return torch.nn.functional.gelu(x, approximate="tanh")
def _silu(x):
    return torch.nn.functional.silu(x)
def _sigmoid(x):
    return torch.sigmoid(x)
def _layernorm(x, axis=-1, eps=1e-5):
    m = x.mean(dim=axis, keepdim=True)
    v = x.var(dim=axis, keepdim=True, unbiased=False)
    return (x - m) / torch.sqrt(v + eps)
def _scatter_add(tgt, idx, src, axis=0):
    return tgt.clone().index_add_(axis, idx, src)
def _segment_sum(src, seg, n):
    out = torch.zeros((n,) + src.shape[1:], dtype=src.dtype)
    return out.index_add_(0, seg, src)
def _pad(x, pw):
    flat = tuple(v for pair in reversed(pw) for v in pair)
    return torch.nn.functional.pad(x, flat)

kernel_name = 'sequential_preLN__mha_block__moe_arch_mod__prompt'

def setup_inputs():

    _w = (lambda a: (lambda t: t.to(torch.bfloat16) if t.is_floating_point() else t)(torch.as_tensor(a)))
    def _A_setup():
        B, S, D, H = 1, 2048, 512, 32
        return {
            "x": _w((lambda *s: torch.randn(*s, dtype=torch.bfloat16) * 0.05)(B, S, D)),
            "wqkv": _w((lambda *s: torch.randn(*s, dtype=torch.bfloat16) * 0.05)(D, 3 * D)),
            "wo": _w((lambda *s: torch.randn(*s, dtype=torch.bfloat16) * 0.05)(D, D)),
        }
    _A_in = _A_setup()

    def _B_setup():
        B, S, D, F, C = 1, 2048, 512, 1792, 1
        return {
            "x": _w((lambda *s: torch.randn(*s, dtype=torch.bfloat16) * 0.05)(B, S, D)),
            "w_r": _w((lambda *s: torch.randn(*s, dtype=torch.bfloat16) * 0.05)(D)),
            "w_gate": _w((lambda *s: torch.randn(*s, dtype=torch.bfloat16) * 0.05)(D, F)),
            "w_up": _w((lambda *s: torch.randn(*s, dtype=torch.bfloat16) * 0.05)(D, F)),
            "w_down": _w((lambda *s: torch.randn(*s, dtype=torch.bfloat16) * 0.05)(F, D)),
        }
    _B_in = _B_setup()

    return {
        "A_x": _A_in["x"],
        "A_wqkv": _A_in["wqkv"],
        "A_wo": _A_in["wo"],
        "B_x": _B_in["x"],
        "B_w_r": _B_in["w_r"],
        "B_w_gate": _B_in["w_gate"],
        "B_w_up": _B_in["w_up"],
        "B_w_down": _B_in["w_down"],
    }

def reference(A_x, A_wqkv, A_wo, B_x, B_w_r, B_w_gate, B_w_up, B_w_down):
    def _A_ref(x, wqkv, wo):
        B, S, D = x.shape
        H = 32
        Dh = D // H
        qkv = (lambda x, *d: x.permute(*d))((x @ wqkv).reshape(B, S, 3, H, Dh), 2, 0, 3, 1, 4)
        q, k, v = qkv[0], qkv[1], qkv[2]
        scores = torch.einsum("bhqd,bhkd->bhqk", q, k) * (Dh ** -0.5)
        p = _softmax(scores, axis=-1)
        o = torch.einsum("bhqk,bhkd->bhqd", p, v)
        return (lambda x, *d: x.permute(*d))(o, 0, 2, 1, 3).reshape(B, S, D) @ wo

    def _B_ref(x, w_r, w_gate, w_up, w_down):
        B, S, D = x.shape
        C = 1
        r = x @ w_r
        idx = torch.argsort(-r, axis=-1)[:, :C]
        idx_e = (lambda x, n, axis: torch.repeat_interleave(x, n, dim=axis))(idx.reshape(B, C, 1), D, axis=2)
        x_sel = (lambda x, i, axis: torch.take_along_dim(x, i, dim=axis))(x, idx_e, axis=1)
        g = _silu(x_sel @ w_gate)
        u = x_sel @ w_up
        y = (g * u) @ w_down
        r_sel = _sigmoid((lambda x, i, axis: torch.take_along_dim(x, i, dim=axis))(r, idx, axis=1))
        y = y * r_sel.reshape(B, C, 1)
        b_off = (torch.arange(B) * S).reshape(B, 1)
        flat_idx = (idx + b_off).reshape(B * C)
        zero = (x * 0.0).reshape(B * S, D)
        upd = _scatter_add(zero, flat_idx, y.reshape(B * C, D), axis=0)
        return x + upd.reshape(B, S, D)

    x = A_x
    h = x + _A_ref(_layernorm(x, axis=-1), A_wqkv, A_wo)
    h2 = h + _B_ref(_layernorm(h, axis=-1), B_w_r, B_w_gate, B_w_up, B_w_down)
    return h2
```

```asm
; @launch grid=(256,1,1) block=(1024,1,1) lds=163840
.amdgcn_target "amdgcn-amd-amdhsa--gfx950"
.text
.globl sequential_preLN__mha_block__moe_arch_mod__prompt_kernel
.p2align 8
.type sequential_preLN__mha_block__moe_arch_mod__prompt_kernel,@function
sequential_preLN__mha_block__moe_arch_mod__prompt_kernel:
    s_cmp_ge_u32 s2, 256
    s_cbranch_scc1 L_end
    s_load_dwordx16 s[64:79], s[0:1], 0
    s_load_dwordx4 s[80:83], s[0:1], 64
    s_load_dwordx2 s[84:85], s[0:1], 80
    s_mov_b32 s3, s2
    s_mov_b32 s91, 0

L_start:
    v_lshrrev_b32 v2, 6, v0
    v_and_b32 v1, 63, v0
    v_readfirstlane_b32 s16, v2
    s_and_b32 s20, s2, 7
    s_lshr_b32 s19, s2, 3
    s_and_b32 s21, s19, 7
    s_and_b32 s17, s16, 1
    s_bfe_u32 s18, s16, 0x10001
    s_mov_b32 s14, 25165824
    s_mov_b32 s15, 0x00020000
    s_mov_b32 s22, 0
    s_mov_b32 s30, 0xffff0000
    s_and_b32 s31, s16, 3
    s_lshr_b32 s23, s16, 2
    s_cmp_lg_u32 s23, 2
    s_cbranch_scc1 L_p1_other

    s_setprio 3
    v_lshrrev_b32 v2, 4, v1
    s_lshl_b32 s23, s17, 2
    v_add_u32 v3, s23, v2
    v_and_b32 v4, 7, v1
    v_xor_b32 v3, v3, v4
    v_lshlrev_b32 v3, 4, v3
    v_lshrrev_b32 v5, 3, v1
    v_lshl_add_u32 v8, v5, 10, v3
    v_and_b32 v2, 1, v2
    v_lshlrev_b32 v2, 2, v2
    v_xor_b32 v2, v2, v4
    v_lshlrev_b32 v2, 4, v2
    v_mul_u32_u24 v5, 3072, v5
    v_add_u32 v9, v5, v2
    s_lshl_b32 s27, s19, 16
    s_lshl_b32 s23, s31, 13
    s_add_u32 s27, s27, s23
    s_mul_i32 s28, s31, 24576
    s_lshl_b32 s23, s20, 7
    s_add_u32 s28, s28, s23
    s_lshl_b32 s32, s31, 10
    s_add_u32 s29, s32, 65536
    s_mov_b32 s34, s21
    s_mov_b32 s6, 0x200000
    s_mov_b32 s7, 0x00020000
    s_mov_b32 s10, 0x180000
    s_mov_b32 s11, 0x00020000
    s_mov_b32 s33, 0
    s_waitcnt lgkmcnt(0)
    s_mov_b32 s4, s64
    s_mov_b32 s5, s65
    s_mov_b32 s8, s66
    s_mov_b32 s9, s67
    s_mov_b32 s12, s84
    s_mov_b32 s13, s85

    s_lshl_b32 s23, s34, 7
    s_add_u32 s23, s23, s27
    s_lshl_b32 s24, s34, 13
    s_add_u32 s24, s24, s32
    s_mov_b32 m0, s24
    s_add_u32 s25, s23, 32768
    buffer_load_dwordx4 v8, s[4:7], s23 offen lds
    s_add_u32 m0, s24, 4096
    s_add_u32 s34, s34, 1
    buffer_load_dwordx4 v8, s[4:7], s25 offen lds
    s_and_b32 s34, s34, 7

L_p1_hloop:
    s_mul_i32 s24, s21, 196608
    s_add_u32 s24, s24, s28
    s_add_u32 s26, s24, 98304

    s_add_u32 m0, s29, 0
    s_nop 0
    buffer_load_dwordx4 v9, s[8:11], s24 offen offset:0 lds
    s_add_u32 m0, s29, 4096
    s_nop 0
    buffer_load_dwordx4 v9, s[8:11], s26 offen offset:0 lds

    s_add_u32 m0, s29, 7168
    s_nop 0
    buffer_load_dwordx4 v9, s[8:11], s24 offen offset:1024 lds
    s_add_u32 m0, s29, 11264
    s_nop 0
    buffer_load_dwordx4 v9, s[8:11], s26 offen offset:1024 lds

    s_add_u32 m0, s29, 14336
    s_nop 0
    buffer_load_dwordx4 v9, s[8:11], s24 offen offset:2048 lds
    s_add_u32 m0, s29, 18432
    s_nop 0
    buffer_load_dwordx4 v9, s[8:11], s26 offen offset:2048 lds

    s_add_u32 s21, s21, 1
    s_and_b32 s21, s21, 7
    s_add_u32 s33, s33, 1
    s_add_u32 s29, s29, 24576
    s_cmp_eq_u32 s33, 4
    s_cselect_b32 s23, 98304, 0
    s_sub_u32 s29, s29, s23

    s_lshl_b32 s23, s34, 7
    s_add_u32 s23, s23, s27
    s_lshl_b32 s24, s34, 13
    s_add_u32 s24, s24, s32
    s_mov_b32 m0, s24
    s_add_u32 s25, s23, 32768
    buffer_load_dwordx4 v8, s[4:7], s23 offen lds
    s_add_u32 m0, s24, 4096
    s_add_u32 s34, s34, 1
    buffer_load_dwordx4 v8, s[4:7], s25 offen lds
    s_and_b32 s34, s34, 7

    s_cmp_eq_u32 s33, 1
    s_cbranch_scc1 L_p1_hloop
    s_waitcnt vmcnt(10)
    s_barrier
    s_cmp_lt_u32 s33, 7
    s_cbranch_scc1 L_p1_hloop

    s_mul_i32 s24, s21, 196608
    s_add_u32 s24, s24, s28
    s_add_u32 s26, s24, 98304

    s_add_u32 m0, s29, 0
    s_nop 0
    buffer_load_dwordx4 v9, s[8:11], s24 offen offset:0 lds
    s_add_u32 m0, s29, 4096
    s_nop 0
    buffer_load_dwordx4 v9, s[8:11], s26 offen offset:0 lds

    s_add_u32 m0, s29, 7168
    s_nop 0
    buffer_load_dwordx4 v9, s[8:11], s24 offen offset:1024 lds
    s_add_u32 m0, s29, 11264
    s_nop 0
    buffer_load_dwordx4 v9, s[8:11], s26 offen offset:1024 lds

    s_add_u32 m0, s29, 14336
    s_nop 0
    buffer_load_dwordx4 v9, s[8:11], s24 offen offset:2048 lds
    s_add_u32 m0, s29, 18432
    s_nop 0
    buffer_load_dwordx4 v9, s[8:11], s26 offen offset:2048 lds

    s_add_u32 s21, s21, 1
    s_and_b32 s21, s21, 7
    s_add_u32 s33, s33, 1
    s_add_u32 s29, s29, 24576
    s_cmp_eq_u32 s33, 4
    s_cselect_b32 s23, 98304, 0
    s_sub_u32 s29, s29, s23

    s_waitcnt vmcnt(8)
    s_barrier
    s_waitcnt vmcnt(0)
    s_barrier

    s_barrier
    s_branch L_p2

L_p1_other:
    s_waitcnt lgkmcnt(0)
    s_mov_b32 s12, s84
    s_mov_b32 s13, s85
    s_cmp_lt_u32 s23, 2
    s_cbranch_scc1 L_p1_mfma

    s_getpc_b64 s[32:33]
L_pc:
    s_lshr_b32 s23, s2, 3
    s_lshl_b32 s24, s31, 5
    s_add_u32 s23, s23, s24
    s_lshl_b32 s23, s23, 10
    s_cmp_ge_u32 s23, (L_code_end - sequential_preLN__mha_block__moe_arch_mod__prompt_kernel - 1023)
    s_cbranch_scc1 L_nocp
    s_sub_u32 s32, s32, (L_pc - sequential_preLN__mha_block__moe_arch_mod__prompt_kernel)
    s_subb_u32 s33, s33, 0
    v_lshl_add_u32 v2, v1, 4, s23
    global_load_dwordx4 v[44:47], v2, s[32:33]
L_nocp:
    v_mov_b32 v12, -1
    v_mov_b32 v13, -1
    v_mov_b32 v14, -1
    v_mov_b32 v15, -1
    v_lshlrev_b32 v2, 4, v1
    s_lshl_b32 s23, s2, 12
    s_lshl_b32 s24, s31, 10
    s_add_u32 s23, s23, s24
    s_add_u32 s23, s23, 8388608
    buffer_store_dwordx4 v[12:15], v2, s[12:15], s23 offen sc1
    s_cmp_lg_u32 s31, 0
    s_cbranch_scc1 L_aux_plain
    s_mov_b32 s4, s82
    s_mov_b32 s5, s83
    s_mov_b32 s6, 256
    s_mov_b32 s7, 0x00020000
    v_mov_b32 v3, 0
    s_getreg_b32 s36, hwreg(HW_REG_XCC_ID)
    s_and_b32 s36, s36, 15
    s_lshl_b32 s36, s36, 28
    s_lshl_b32 s23, s3, 20
    s_or_b32 s36, s36, s23
    s_or_b32 s23, s3, s91
    s_cmp_lg_u32 s23, 0
    s_cbranch_scc1 L_ep_rd
    s_memrealtime s[34:35]
    s_waitcnt lgkmcnt(0)
    s_or_b32 s34, s34, 1
    s_and_b32 s35, s35, 0x000fffff
    v_mov_b32 v32, s34
    v_mov_b32 v33, s35
    s_mov_b64 exec, 1
    buffer_store_dwordx2 v[32:33], v3, s[4:7], 0 offen sc1
    s_mov_b64 exec, -1
L_ep_rd:
    s_mov_b32 s90, 0
L_ep_loop:
    buffer_load_dwordx2 v[32:33], v3, s[4:7], 0 offen sc1
    s_add_u32 s90, s90, 1
    s_waitcnt vmcnt(0)
    v_readfirstlane_b32 s34, v32
    v_readfirstlane_b32 s35, v33
    s_cmp_ge_u32 s90, 200000
    s_cbranch_scc1 L_ep_done
    s_cmp_eq_u32 s34, 0
    s_cbranch_scc1 L_ep_loop
L_ep_done:
    s_lshl_b32 s23, s91, 1
    s_add_u32 s34, s34, s23
    s_or_b32 s37, s35, s36
    s_mov_b32 s36, s34
    v_mov_b32 v32, s34
    v_mov_b32 v33, s37
    s_lshl_b32 s38, s20, 8
    s_add_u32 s38, s38, 10539008
    s_lshl_b32 s24, s19, 3
    s_add_u32 s24, s24, s38
    s_mov_b64 exec, 1
    buffer_store_dwordx2 v[32:33], v3, s[12:15], s24 offen sc1
    s_mov_b64 exec, -1
    v_and_b32 v6, 31, v1
    v_lshlrev_b32 v6, 3, v6
    s_branch L_p1_stat
L_aux_plain:
    s_lshl_b32 s38, s20, 18
    s_lshl_b32 s24, s19, 11
    s_add_u32 s38, s38, s24
    v_lshrrev_b32 v2, 4, v1
    v_and_b32 v3, 15, v1
    v_lshlrev_b32 v2, 16, v2
    s_cmp_eq_u32 s31, 1
    s_cbranch_scc1 L_pt
    s_lshl_b32 s38, s38, 1
    s_add_u32 s38, s38, 2097152
    s_sub_u32 s24, s31, 2
    s_lshl_b32 s24, s24, 18
    s_add_u32 s38, s38, s24
    v_lshrrev_b32 v2, 5, v1
    v_and_b32 v3, 31, v1
    v_lshlrev_b32 v2, 17, v2
L_pt:
    v_lshl_add_u32 v6, v3, 7, v2
L_p1_stat:
    v_lshlrev_b32 v7, 3, v1
    v_mov_b32 v5, 0
    s_mov_b32 s28, 10539008
    s_cmp_eq_u32 s31, 0
    s_cselect_b32 s39, 5, 7
    s_lshl_b32 s23, s31, 11
    s_lshl_b32 s24, s21, 13
    s_add_u32 s23, s23, s24
    v_lshl_add_u32 v10, v1, 4, s23

    v_mov_b32 v24, 0
    v_mov_b32 v25, 0
    v_mov_b32 v26, 0
    v_mov_b32 v27, 0
    v_mov_b32 v28, 0
    v_mov_b32 v29, 0
    v_mov_b32 v30, 0
    v_mov_b32 v31, 0
L_p1_sloop:
    s_cmp_lg_u32 s22, s39
    s_cbranch_scc1 L_p1_snl
    buffer_load_dwordx2 v[34:35], v6, s[12:15], s38 offen nt
    s_cmp_lg_u32 s31, 0
    s_cbranch_scc1 L_p1_snl
    buffer_load_dwordx2 v[48:49], v7, s[12:15], s28 offen sc1
    buffer_load_dwordx2 v[50:51], v7, s[12:15], s28 offen offset:512 sc1
    buffer_load_dwordx2 v[52:53], v7, s[12:15], s28 offen offset:1024 sc1
    buffer_load_dwordx2 v[54:55], v7, s[12:15], s28 offen offset:1536 sc1
    buffer_load_dwordx2 v[56:57], v5, s[12:15], s28 offen offset:2048 sc1
L_p1_snl:
    s_barrier

    ds_read_b128 v[12:15], v10
    ds_read_b128 v[16:19], v10 offset:1024
    v_add_u32 v10, 0x2000, v10
    v_and_b32 v10, 0xffff, v10
    s_waitcnt lgkmcnt(1)

    v_lshlrev_b32 v20, 16, v12
    v_and_b32 v21, s30, v12
    v_add_f32 v24, v24, v20
    v_add_f32 v25, v25, v21
    v_fmac_f32 v26, v20, v20
    v_fmac_f32 v27, v21, v21

    v_lshlrev_b32 v22, 16, v13
    v_and_b32 v23, s30, v13
    v_add_f32 v24, v24, v22
    v_add_f32 v25, v25, v23
    v_fmac_f32 v26, v22, v22
    v_fmac_f32 v27, v23, v23

    v_lshlrev_b32 v20, 16, v14
    v_and_b32 v21, s30, v14
    v_add_f32 v24, v24, v20
    v_add_f32 v25, v25, v21
    v_fmac_f32 v26, v20, v20
    v_fmac_f32 v27, v21, v21

    v_lshlrev_b32 v22, 16, v15
    v_and_b32 v23, s30, v15
    v_add_f32 v24, v24, v22
    v_add_f32 v25, v25, v23
    v_fmac_f32 v26, v22, v22
    v_fmac_f32 v27, v23, v23

    s_waitcnt lgkmcnt(0)
    v_lshlrev_b32 v20, 16, v16
    v_and_b32 v21, s30, v16
    v_add_f32 v28, v28, v20
    v_add_f32 v29, v29, v21
    v_fmac_f32 v30, v20, v20
    v_fmac_f32 v31, v21, v21

    v_lshlrev_b32 v22, 16, v17
    v_and_b32 v23, s30, v17
    v_add_f32 v28, v28, v22
    v_add_f32 v29, v29, v23
    v_fmac_f32 v30, v22, v22
    v_fmac_f32 v31, v23, v23

    v_lshlrev_b32 v20, 16, v18
    v_and_b32 v21, s30, v18
    v_add_f32 v28, v28, v20
    v_add_f32 v29, v29, v21
    v_fmac_f32 v30, v20, v20
    v_fmac_f32 v31, v21, v21

    v_lshlrev_b32 v22, 16, v19
    v_and_b32 v23, s30, v19
    v_add_f32 v28, v28, v22
    v_add_f32 v29, v29, v23
    v_fmac_f32 v30, v22, v22
    v_fmac_f32 v31, v23, v23

    s_add_u32 s22, s22, 1
    s_cmp_lt_u32 s22, 8
    s_cbranch_scc1 L_p1_sloop
    s_setprio 3

    v_add_f32 v24, v24, v25
    v_add_f32 v26, v26, v27
    v_add_f32 v28, v28, v29
    v_add_f32 v30, v30, v31
    s_nop 1
    v_add_f32_dpp v24, v24, v24 quad_perm:[1,0,3,2] row_mask:0xf bank_mask:0xf
    v_add_f32_dpp v26, v26, v26 quad_perm:[1,0,3,2] row_mask:0xf bank_mask:0xf
    v_add_f32_dpp v28, v28, v28 quad_perm:[1,0,3,2] row_mask:0xf bank_mask:0xf
    v_add_f32_dpp v30, v30, v30 quad_perm:[1,0,3,2] row_mask:0xf bank_mask:0xf
    s_nop 1
    v_add_f32_dpp v24, v24, v24 quad_perm:[2,3,0,1] row_mask:0xf bank_mask:0xf
    v_add_f32_dpp v26, v26, v26 quad_perm:[2,3,0,1] row_mask:0xf bank_mask:0xf
    v_add_f32_dpp v28, v28, v28 quad_perm:[2,3,0,1] row_mask:0xf bank_mask:0xf
    v_add_f32_dpp v30, v30, v30 quad_perm:[2,3,0,1] row_mask:0xf bank_mask:0xf
    s_nop 1
    v_add_f32_dpp v24, v24, v24 row_half_mirror row_mask:0xf bank_mask:0xf
    v_add_f32_dpp v26, v26, v26 row_half_mirror row_mask:0xf bank_mask:0xf
    v_add_f32_dpp v28, v28, v28 row_half_mirror row_mask:0xf bank_mask:0xf
    v_add_f32_dpp v30, v30, v30 row_half_mirror row_mask:0xf bank_mask:0xf
    v_mul_f32 v24, 0x3b000000, v24
    v_mul_f32 v26, 0x3b000000, v26
    v_fma_f32 v26, -v24, v24, v26
    v_max_f32 v26, 0, v26
    v_add_f32 v26, 0x3727c5ac, v26
    v_rsq_f32 v26, v26

    v_mul_f32 v28, 0x3b000000, v28
    v_mul_f32 v30, 0x3b000000, v30
    v_fma_f32 v30, -v28, v28, v30
    v_max_f32 v30, 0, v30
    v_add_f32 v30, 0x3727c5ac, v30
    v_rsq_f32 v30, v30

    v_lshrrev_b32 v2, 3, v1
    s_lshl_b32 s23, s31, 6
    s_add_u32 s23, s23, 65536
    v_lshl_add_u32 v2, v2, 2, s23
    ds_write_b32 v2, v24
    ds_write_b32 v2, v26 offset:256
    ds_write_b32 v2, v28 offset:32
    ds_write_b32 v2, v30 offset:288
    s_waitcnt vmcnt(1)
    s_cmp_lg_u32 s31, 0
    s_cbranch_scc1 L_noep
    s_mov_b32 s90, 0
    s_mov_b32 s25, 0x000fffff
    s_mov_b32 s26, 0
    s_branch L_xtc
L_xt:
    buffer_load_dwordx2 v[48:49], v7, s[12:15], s28 offen sc1
    buffer_load_dwordx2 v[50:51], v7, s[12:15], s28 offen offset:512 sc1
    buffer_load_dwordx2 v[52:53], v7, s[12:15], s28 offen offset:1024 sc1
    buffer_load_dwordx2 v[54:55], v7, s[12:15], s28 offen offset:1536 sc1
    buffer_load_dwordx2 v[56:57], v5, s[12:15], s28 offen offset:2048 sc1
    buffer_load_dwordx2 v[34:35], v6, s[12:15], s38 offen sc1
L_xtc:
    s_add_u32 s90, s90, 1
    s_waitcnt vmcnt(0)
    v_readlane_b32 s24, v35, s19
    v_and_b32 v49, s25, v49
    v_and_b32 v51, s25, v51
    v_and_b32 v53, s25, v53
    v_and_b32 v55, s25, v55
    v_cmp_ne_u64 vcc, s[34:35], v[48:49]
    v_cmp_ne_u64 s[40:41], s[34:35], v[50:51]
    v_cmp_ne_u64 s[42:43], s[34:35], v[52:53]
    v_cmp_ne_u64 s[44:45], s[34:35], v[54:55]
    v_cmp_eq_u64 s[46:47], s[34:35], v[56:57]
    s_or_b64 vcc, vcc, s[40:41]
    s_or_b64 s[42:43], s[42:43], s[44:45]
    s_or_b64 vcc, vcc, s[42:43]
    s_cbranch_vccz L_xtd
    s_cmp_lg_u64 s[46:47], 0
    s_cbranch_scc1 L_xta
    s_cmp_lg_u32 s24, s37
    s_cbranch_scc1 L_xtr
    s_cmp_lt_u32 s90, 200000
    s_cbranch_scc1 L_xt
    s_branch L_xtd
L_xtr:
    v_mov_b32 v32, s34
    v_mov_b32 v33, s35
    s_mov_b64 exec, 1
    buffer_store_dwordx2 v[32:33], v5, s[12:15], s28 offen offset:2048 sc1
    s_mov_b64 exec, -1
L_xta:
    s_mov_b32 s26, 2
L_xtd:
    v_lshrrev_b32 v35, 28, v35
    s_lshr_b32 s24, s37, 28
    v_mov_b32 v3, 68608
    v_cmp_ne_u32 vcc, s24, v35
    v_mov_b32 v32, s34
    v_mov_b32 v33, s35
    s_cmp_eq_u64 vcc, 0
    s_cselect_b32 s23, 1, 0
    s_cmp_eq_u32 s26, 0
    s_cselect_b32 s23, s23, 2
    v_mov_b32 v34, s23
    ds_write_b96 v3, v[32:34]
L_noep:
    s_waitcnt lgkmcnt(0)
    s_barrier

    s_branch L_p2
L_p1_mfma:
    s_setprio 2
    v_lshrrev_b32 v2, 5, v1
    v_bfe_u32 v3, v1, 2, 2
    v_lshl_add_u32 v4, v2, 3, v3
    v_lshlrev_b32 v4, 7, v4
    v_lshrrev_b32 v3, 1, v3
    v_xor_b32 v3, s18, v3
    v_lshl_add_u32 v4, v3, 6, v4
    v_bfe_u32 v3, v1, 4, 1
    v_lshl_add_u32 v4, v3, 5, v4
    v_and_b32 v3, 3, v1
    v_lshl_add_u32 v5, v3, 3, v4
    s_lshl_b32 s25, s17, 13
    s_xor_b32 s26, s25, 8192
    s_cmp_eq_u32 s23, 1
    s_cselect_b32 s25, 16384, s25
    s_add_u32 s25, s25, 65536
    s_add_u32 s26, s26, 65536
    v_add_u32 v8, s25, v5
    v_add_u32 v9, s26, v5
    v_and_b32 v3, 31, v1
    v_bfe_u32 v4, v1, 1, 3
    v_xor_b32 v4, v4, v2
    v_lshlrev_b32 v4, 4, v4
    v_lshl_add_u32 v4, v3, 7, v4
    s_lshl_b32 s25, s17, 12
    s_lshl_b32 s24, s21, 13
    s_add_u32 s25, s25, s24
    v_add_u32 v12, s25, v4
    v_xor_b32 v13, 32, v12
    v_xor_b32 v14, 64, v12
    v_xor_b32 v15, 0x60, v12
    v_and_b32 v3, 15, v1
    v_bfe_u32 v5, v1, 4, 1
    v_mov_b32 v4, 0x3f803f80
    v_cmp_eq_u32 vcc, v5, v3
    s_mov_b32 s40, 24576
    s_mov_b32 s41, 8192
    v_cndmask_b32 v16, 0, v4, vcc
    s_lshl_b32 s24, s20, 2
    s_lshl_b32 s25, s18, 1
    s_add_u32 s24, s24, s25
    s_lshl_b32 s25, s19, 1
    s_add_u32 s25, s25, s17
    s_lshl_b32 s26, s24, 16
    s_lshl_b32 s27, s25, 10
    s_add_u32 s26, s26, s27
    s_lshl_b32 s28, s26, 1
    s_add_u32 s28, s28, 2097152
    s_lshl_b32 s29, s24, 9
    s_lshl_b32 s27, s25, 3
    s_add_u32 s29, s29, s27
    s_lshl_b32 s27, s23, 9
    s_add_u32 s29, s29, s27
    s_add_u32 s29, s29, 10485760

    v_mov_b32 v17, v16
    v_mov_b32 v18, v16
    v_mov_b32 v19, v16
    v_mov_b32 v68, 0
    v_mov_b32 v69, 0
    v_mov_b32 v70, 0
    v_mov_b32 v71, 0
    v_mov_b32 v72, 0
    v_mov_b32 v73, 0
    v_mov_b32 v74, 0
    v_mov_b32 v75, 0
    v_mov_b32 v76, 0
    v_mov_b32 v77, 0
    v_mov_b32 v78, 0
    v_mov_b32 v79, 0
    v_mov_b32 v80, 0
    v_mov_b32 v81, 0
    v_mov_b32 v82, 0
    v_mov_b32 v83, 0
    v_mov_b32 v84, 0
    v_mov_b32 v85, 0
    v_mov_b32 v86, 0
    v_mov_b32 v87, 0
    v_mov_b32 v88, 0
    v_mov_b32 v89, 0
    v_mov_b32 v90, 0
    v_mov_b32 v91, 0
    v_mov_b32 v92, 0
    v_mov_b32 v93, 0
    v_mov_b32 v94, 0
    v_mov_b32 v95, 0
    v_mov_b32 v96, 0
    v_mov_b32 v97, 0
    v_mov_b32 v98, 0
    v_mov_b32 v99, 0
    v_mov_b32 v100, 0
    v_mov_b32 v101, 0
    v_mov_b32 v102, 0
    v_mov_b32 v103, 0
    s_cmp_eq_u32 s23, 1
    s_cbranch_scc1 L_p1_v
    s_barrier
    ds_read_b128 v[20:23], v12
    ds_read_b64_tr_b16 v[36:37], v8 offset:0
    ds_read_b64_tr_b16 v[38:39], v8 offset:512
    ds_read_b64_tr_b16 v[40:41], v9 offset:0
    ds_read_b64_tr_b16 v[42:43], v9 offset:512
    ds_read_b128 v[24:27], v13
    ds_read_b64_tr_b16 v[44:45], v8 offset:2048
    ds_read_b64_tr_b16 v[46:47], v8 offset:2560
    ds_read_b64_tr_b16 v[48:49], v9 offset:2048
    ds_read_b64_tr_b16 v[50:51], v9 offset:2560
L_p1_qloop:
    ds_read_b128 v[28:31], v14
    ds_read_b64_tr_b16 v[52:53], v8 offset:4096
    ds_read_b64_tr_b16 v[54:55], v8 offset:4608
    ds_read_b64_tr_b16 v[56:57], v9 offset:4096
    ds_read_b64_tr_b16 v[58:59], v9 offset:4608
    s_waitcnt lgkmcnt(12)
    v_mfma_f32_16x16x32_bf16 v[100:103], v[16:19], v[36:39], v[100:103]
    v_mfma_f32_32x32x16_bf16 v[68:83], v[36:39], v[20:23], v[68:83]
    s_cmp_eq_u32 s22, 3
    s_cselect_b32 s38, 4294893568, s40
    s_cmp_eq_u32 s21, 7
    s_cselect_b32 s39, 4294909952, s41
    s_waitcnt lgkmcnt(10)
    v_mfma_f32_32x32x16_bf16 v[84:99], v[40:43], v[20:23], v[84:99]
    s_add_u32 s21, s21, 1
    s_and_b32 s21, s21, 7
    ds_read_b128 v[32:35], v15
    ds_read_b64_tr_b16 v[60:61], v8 offset:6144
    ds_read_b64_tr_b16 v[62:63], v8 offset:6656
    ds_read_b64_tr_b16 v[64:65], v9 offset:6144
    ds_read_b64_tr_b16 v[66:67], v9 offset:6656
    s_waitcnt lgkmcnt(12)
    v_mfma_f32_16x16x32_bf16 v[100:103], v[16:19], v[44:47], v[100:103]
    v_mfma_f32_32x32x16_bf16 v[68:83], v[44:47], v[24:27], v[68:83]
    v_add_u32 v8, s38, v8
    v_add_u32 v12, s39, v12
    v_add_u32 v13, s39, v13
    v_add_u32 v14, s39, v14
    s_waitcnt lgkmcnt(10)
    v_mfma_f32_32x32x16_bf16 v[84:99], v[48:51], v[24:27], v[84:99]
    v_add_u32 v9, s38, v9
    v_add_u32 v15, s39, v15
    s_add_u32 s22, s22, 1
    s_cmp_eq_u32 s22, 8
    s_cbranch_scc1 L_p1_qtail
    s_barrier

    ds_read_b128 v[20:23], v12
    ds_read_b64_tr_b16 v[36:37], v8 offset:0
    ds_read_b64_tr_b16 v[38:39], v8 offset:512
    ds_read_b64_tr_b16 v[40:41], v9 offset:0
    ds_read_b64_tr_b16 v[42:43], v9 offset:512
    s_waitcnt lgkmcnt(12)
    v_mfma_f32_16x16x32_bf16 v[100:103], v[16:19], v[52:55], v[100:103]
    v_mfma_f32_32x32x16_bf16 v[68:83], v[52:55], v[28:31], v[68:83]
    s_waitcnt lgkmcnt(10)
    v_mfma_f32_32x32x16_bf16 v[84:99], v[56:59], v[28:31], v[84:99]
    ds_read_b128 v[24:27], v13
    ds_read_b64_tr_b16 v[44:45], v8 offset:2048
    ds_read_b64_tr_b16 v[46:47], v8 offset:2560
    ds_read_b64_tr_b16 v[48:49], v9 offset:2048
    ds_read_b64_tr_b16 v[50:51], v9 offset:2560
    s_waitcnt lgkmcnt(12)
    v_mfma_f32_16x16x32_bf16 v[100:103], v[16:19], v[60:63], v[100:103]
    v_mfma_f32_32x32x16_bf16 v[68:83], v[60:63], v[32:35], v[68:83]
    s_waitcnt lgkmcnt(10)
    v_mfma_f32_32x32x16_bf16 v[84:99], v[64:67], v[32:35], v[84:99]
    s_branch L_p1_qloop
L_p1_qtail:
    s_lshl_b32 s23, s18, 9
    s_add_u32 s23, s23, 66048
    v_and_b32 v2, 31, v1
    v_lshrrev_b32 v4, 5, v1
    s_lshl_b32 s24, s17, 7
    s_add_u32 s25, s23, s24
    v_lshl_add_u32 v3, v2, 2, s25
    s_waitcnt lgkmcnt(7)
    v_mfma_f32_16x16x32_bf16 v[100:103], v[16:19], v[52:55], v[100:103]
    v_lshl_add_u32 v5, v4, 4, s25
    s_xor_b32 s25, s24, 128
    s_add_u32 s25, s25, s23
    v_lshl_add_u32 v6, v4, 4, s25
    s_add_u32 s23, s24, 65536
    v_lshl_add_u32 v7, v2, 2, s23
    s_waitcnt lgkmcnt(2)
    v_mfma_f32_16x16x32_bf16 v[100:103], v[16:19], v[60:63], v[100:103]

    v_mfma_f32_32x32x16_bf16 v[68:83], v[52:55], v[28:31], v[68:83]
    s_mov_b32 s31, 0x3eb8aa3b
    s_cmp_eq_u32 s17, 0
    s_cselect_b32 s32, s26, s28
    s_cselect_b32 s33, s28, s26
    s_cselect_b32 s36, s31, 1.0
    s_cselect_b32 s37, 1.0, s31
    s_lshl_b32 s34, 65536, s17
    s_lshr_b32 s35, 131072, s17
    s_add_u32 s34, s34, s32
    s_add_u32 s35, s35, s33
    v_mfma_f32_32x32x16_bf16 v[84:99], v[56:59], v[28:31], v[84:99]
    s_mov_b64 exec, 0xffff
    ds_write_b32 v3, v100
    ds_write_b32 v3, v101 offset:64
    s_mov_b64 exec, -1
    v_lshlrev_b32 v2, 4, v1
    v_mov_b32 v3, 68608
    s_waitcnt lgkmcnt(0)
    s_barrier
    v_mfma_f32_32x32x16_bf16 v[68:83], v[60:63], v[32:35], v[68:83]
    ds_read_b96 v[112:114], v3
    ds_read_b32 v104, v7
    ds_read_b32 v106, v7 offset:256
    ds_read_b128 v[36:39], v5 offset:0
    ds_read_b128 v[40:43], v5 offset:32
    ds_read_b128 v[44:47], v5 offset:64
    ds_read_b128 v[48:51], v5 offset:96
    v_mfma_f32_32x32x16_bf16 v[84:99], v[64:67], v[32:35], v[84:99]
    ds_read_b128 v[20:23], v6 offset:0
    ds_read_b128 v[24:27], v6 offset:32
    ds_read_b128 v[28:31], v6 offset:64
    ds_read_b128 v[52:55], v6 offset:96
    s_waitcnt lgkmcnt(8)
    v_sub_f32 v104, 0, v104
    v_mul_f32 v108, s36, v106
    v_mul_f32 v110, s37, v106
    v_readfirstlane_b32 s39, v114
    s_waitcnt lgkmcnt(4)

    v_pk_fma_f32 v[68:69], v[104:105], v[36:37], v[68:69] op_sel_hi:[0,1,1]
    v_pk_fma_f32 v[70:71], v[104:105], v[38:39], v[70:71] op_sel_hi:[0,1,1]
    v_pk_fma_f32 v[72:73], v[104:105], v[40:41], v[72:73] op_sel_hi:[0,1,1]
    v_pk_fma_f32 v[74:75], v[104:105], v[42:43], v[74:75] op_sel_hi:[0,1,1]
    v_pk_fma_f32 v[76:77], v[104:105], v[44:45], v[76:77] op_sel_hi:[0,1,1]
    v_pk_fma_f32 v[78:79], v[104:105], v[46:47], v[78:79] op_sel_hi:[0,1,1]
    v_pk_fma_f32 v[80:81], v[104:105], v[48:49], v[80:81] op_sel_hi:[0,1,1]
    v_pk_fma_f32 v[82:83], v[104:105], v[50:51], v[82:83] op_sel_hi:[0,1,1]
    s_cmp_eq_u32 s39, 1
    v_pk_mul_f32 v[68:69], v[108:109], v[68:69] op_sel_hi:[0,1]
    v_pk_mul_f32 v[70:71], v[108:109], v[70:71] op_sel_hi:[0,1]
    v_pk_mul_f32 v[72:73], v[108:109], v[72:73] op_sel_hi:[0,1]
    v_pk_mul_f32 v[74:75], v[108:109], v[74:75] op_sel_hi:[0,1]
    v_pk_mul_f32 v[76:77], v[108:109], v[76:77] op_sel_hi:[0,1]
    v_pk_mul_f32 v[78:79], v[108:109], v[78:79] op_sel_hi:[0,1]
    v_pk_mul_f32 v[80:81], v[108:109], v[80:81] op_sel_hi:[0,1]
    v_pk_mul_f32 v[82:83], v[108:109], v[82:83] op_sel_hi:[0,1]
    v_cvt_pk_bf16_f32 v68, v68, v69
    v_cvt_pk_bf16_f32 v69, v70, v71
    v_cvt_pk_bf16_f32 v70, v72, v73
    v_cvt_pk_bf16_f32 v71, v74, v75
    v_cvt_pk_bf16_f32 v72, v76, v77
    v_cvt_pk_bf16_f32 v73, v78, v79
    v_cvt_pk_bf16_f32 v74, v80, v81
    v_cvt_pk_bf16_f32 v75, v82, v83
    s_cbranch_scc1 L_st1a
    buffer_store_dwordx4 v[68:71], v2, s[12:15], s32 offen sc1
    buffer_store_dwordx4 v[72:75], v2, s[12:15], s34 offen sc1
    s_branch L_st1b
L_st1a:
    buffer_store_dwordx4 v[68:71], v2, s[12:15], s32 offen
    buffer_store_dwordx4 v[72:75], v2, s[12:15], s34 offen
L_st1b:

    s_waitcnt lgkmcnt(0)
    v_pk_fma_f32 v[84:85], v[104:105], v[20:21], v[84:85] op_sel_hi:[0,1,1]
    v_pk_fma_f32 v[86:87], v[104:105], v[22:23], v[86:87] op_sel_hi:[0,1,1]
    v_pk_fma_f32 v[88:89], v[104:105], v[24:25], v[88:89] op_sel_hi:[0,1,1]
    v_pk_fma_f32 v[90:91], v[104:105], v[26:27], v[90:91] op_sel_hi:[0,1,1]
    v_pk_fma_f32 v[92:93], v[104:105], v[28:29], v[92:93] op_sel_hi:[0,1,1]
    v_pk_fma_f32 v[94:95], v[104:105], v[30:31], v[94:95] op_sel_hi:[0,1,1]
    v_pk_fma_f32 v[96:97], v[104:105], v[52:53], v[96:97] op_sel_hi:[0,1,1]
    v_pk_fma_f32 v[98:99], v[104:105], v[54:55], v[98:99] op_sel_hi:[0,1,1]
    v_pk_mul_f32 v[84:85], v[110:111], v[84:85] op_sel_hi:[0,1]
    v_pk_mul_f32 v[86:87], v[110:111], v[86:87] op_sel_hi:[0,1]
    v_pk_mul_f32 v[88:89], v[110:111], v[88:89] op_sel_hi:[0,1]
    v_pk_mul_f32 v[90:91], v[110:111], v[90:91] op_sel_hi:[0,1]
    v_pk_mul_f32 v[92:93], v[110:111], v[92:93] op_sel_hi:[0,1]
    v_pk_mul_f32 v[94:95], v[110:111], v[94:95] op_sel_hi:[0,1]
    v_pk_mul_f32 v[96:97], v[110:111], v[96:97] op_sel_hi:[0,1]
    v_pk_mul_f32 v[98:99], v[110:111], v[98:99] op_sel_hi:[0,1]
    v_cvt_pk_bf16_f32 v84, v84, v85
    v_cvt_pk_bf16_f32 v85, v86, v87
    v_cvt_pk_bf16_f32 v86, v88, v89
    v_cvt_pk_bf16_f32 v87, v90, v91
    v_cvt_pk_bf16_f32 v88, v92, v93
    v_cvt_pk_bf16_f32 v89, v94, v95
    v_cvt_pk_bf16_f32 v90, v96, v97
    v_cvt_pk_bf16_f32 v91, v98, v99
    s_cbranch_scc1 L_st2a
    buffer_store_dwordx4 v[84:87], v2, s[12:15], s33 offen sc1
    buffer_store_dwordx4 v[88:91], v2, s[12:15], s35 offen sc1
    s_branch L_st2b
L_st2a:
    buffer_store_dwordx4 v[84:87], v2, s[12:15], s33 offen
    buffer_store_dwordx4 v[88:91], v2, s[12:15], s35 offen
L_st2b:

    v_mov_b32 v3, 0
    s_waitcnt vmcnt(0)
    s_mov_b64 exec, 1

    s_cbranch_scc1 L_st4a
    buffer_store_dwordx2 v[112:113], v3, s[12:15], s29 offen sc1
    s_nop 0
    s_branch L_st4b
L_st4a:
    buffer_store_dwordx2 v[112:113], v3, s[12:15], s29 offen
    s_nop 0
L_st4b:

    s_mov_b64 exec, -1
    s_branch L_p2
L_p1_v:
    s_barrier
    ds_read_b128 v[20:23], v12
    ds_read_b64_tr_b16 v[36:37], v8 offset:0
    ds_read_b64_tr_b16 v[38:39], v8 offset:512
    ds_read_b128 v[24:27], v13
    ds_read_b64_tr_b16 v[40:41], v8 offset:2048
    ds_read_b64_tr_b16 v[42:43], v8 offset:2560
L_p1_vloop:
    ds_read_b128 v[28:31], v14
    ds_read_b64_tr_b16 v[44:45], v8 offset:4096
    ds_read_b64_tr_b16 v[46:47], v8 offset:4608
    s_waitcnt lgkmcnt(6)
    v_mfma_f32_32x32x16_bf16 v[68:83], v[20:23], v[36:39], v[68:83]
    v_mfma_f32_16x16x32_bf16 v[100:103], v[16:19], v[36:39], v[100:103]
    s_cmp_eq_u32 s22, 3
    s_cselect_b32 s38, 4294893568, s40
    s_cmp_eq_u32 s21, 7
    s_cselect_b32 s39, 4294909952, s41
    s_add_u32 s21, s21, 1
    s_and_b32 s21, s21, 7
    ds_read_b128 v[32:35], v15
    ds_read_b64_tr_b16 v[48:49], v8 offset:6144
    ds_read_b64_tr_b16 v[50:51], v8 offset:6656
    s_waitcnt lgkmcnt(6)
    v_mfma_f32_32x32x16_bf16 v[68:83], v[24:27], v[40:43], v[68:83]
    v_mfma_f32_16x16x32_bf16 v[100:103], v[16:19], v[40:43], v[100:103]
    v_add_u32 v8, s38, v8
    v_add_u32 v12, s39, v12
    v_add_u32 v13, s39, v13
    v_add_u32 v14, s39, v14
    v_add_u32 v15, s39, v15
    s_add_u32 s22, s22, 1
    s_cmp_eq_u32 s22, 8
    s_cbranch_scc1 L_p1_vtail

    s_barrier

    ds_read_b128 v[20:23], v12
    ds_read_b64_tr_b16 v[36:37], v8 offset:0
    ds_read_b64_tr_b16 v[38:39], v8 offset:512
    s_waitcnt lgkmcnt(6)
    v_mfma_f32_32x32x16_bf16 v[68:83], v[28:31], v[44:47], v[68:83]
    v_mfma_f32_16x16x32_bf16 v[100:103], v[16:19], v[44:47], v[100:103]
    ds_read_b128 v[24:27], v13
    ds_read_b64_tr_b16 v[40:41], v8 offset:2048
    ds_read_b64_tr_b16 v[42:43], v8 offset:2560
    s_waitcnt lgkmcnt(6)
    v_mfma_f32_32x32x16_bf16 v[68:83], v[32:35], v[48:51], v[68:83]
    v_mfma_f32_16x16x32_bf16 v[100:103], v[16:19], v[48:51], v[100:103]
    s_branch L_p1_vloop
L_p1_vtail:
    s_waitcnt lgkmcnt(3)
    v_mfma_f32_32x32x16_bf16 v[68:83], v[28:31], v[44:47], v[68:83]
    v_mfma_f32_16x16x32_bf16 v[100:103], v[16:19], v[44:47], v[100:103]
    s_waitcnt lgkmcnt(0)
    v_mfma_f32_32x32x16_bf16 v[68:83], v[32:35], v[48:51], v[68:83]
    v_mfma_f32_16x16x32_bf16 v[100:103], v[16:19], v[48:51], v[100:103]
    s_lshl_b32 s23, s31, 7
    s_add_u32 s23, s23, 67584
    v_and_b32 v2, 31, v1
    v_lshrrev_b32 v4, 5, v1
    v_lshl_add_u32 v3, v2, 2, s23
    s_lshl_b32 s24, s17, 7
    s_add_u32 s23, s24, 65536
    v_lshl_add_u32 v7, v4, 4, s23
    v_bfe_u32 v6, v1, 4, 1
    v_lshlrev_b32 v6, 17, v6
    v_lshl_add_u32 v6, v4, 9, v6
    v_and_b32 v4, 15, v1
    v_lshl_add_u32 v6, v4, 4, v6
    v_mov_b32 v5, 68608
    s_mov_b64 exec, 0xffff
    ds_write_b32 v3, v100
    ds_write_b32 v3, v101 offset:64
    s_mov_b64 exec, -1
    s_waitcnt lgkmcnt(0)
    s_barrier
    ds_read_b96 v[112:114], v5
    ds_read_b32 v104, v3

    ds_read_b128 v[36:39], v7 offset:0
    ds_read_b128 v[40:43], v7 offset:32
    ds_read_b128 v[44:47], v7 offset:64
    ds_read_b128 v[48:51], v7 offset:96
    ds_read_b128 v[20:23], v7 offset:256
    ds_read_b128 v[24:27], v7 offset:288
    ds_read_b128 v[28:31], v7 offset:320
    ds_read_b128 v[32:35], v7 offset:352
    s_waitcnt lgkmcnt(8)
    v_sub_f32 v104, 0, v104
    v_readfirstlane_b32 s39, v114
    s_waitcnt lgkmcnt(4)

    v_pk_fma_f32 v[68:69], v[104:105], v[36:37], v[68:69] op_sel_hi:[0,1,1]
    v_pk_fma_f32 v[70:71], v[104:105], v[38:39], v[70:71] op_sel_hi:[0,1,1]
    v_pk_fma_f32 v[72:73], v[104:105], v[40:41], v[72:73] op_sel_hi:[0,1,1]
    v_pk_fma_f32 v[74:75], v[104:105], v[42:43], v[74:75] op_sel_hi:[0,1,1]
    v_pk_fma_f32 v[76:77], v[104:105], v[44:45], v[76:77] op_sel_hi:[0,1,1]
    v_pk_fma_f32 v[78:79], v[104:105], v[46:47], v[78:79] op_sel_hi:[0,1,1]
    v_pk_fma_f32 v[80:81], v[104:105], v[48:49], v[80:81] op_sel_hi:[0,1,1]
    v_pk_fma_f32 v[82:83], v[104:105], v[50:51], v[82:83] op_sel_hi:[0,1,1]
    s_cmp_eq_u32 s39, 1
    s_waitcnt lgkmcnt(0)
    v_pk_mul_f32 v[68:69], v[68:69], v[20:21]
    v_pk_mul_f32 v[70:71], v[70:71], v[22:23]
    v_pk_mul_f32 v[72:73], v[72:73], v[24:25]
    v_pk_mul_f32 v[74:75], v[74:75], v[26:27]
    v_pk_mul_f32 v[76:77], v[76:77], v[28:29]
    v_pk_mul_f32 v[78:79], v[78:79], v[30:31]
    v_pk_mul_f32 v[80:81], v[80:81], v[32:33]
    v_pk_mul_f32 v[82:83], v[82:83], v[34:35]
    v_cvt_pk_bf16_f32 v68, v68, v69
    v_cvt_pk_bf16_f32 v69, v70, v71
    v_cvt_pk_bf16_f32 v70, v72, v73
    v_cvt_pk_bf16_f32 v71, v74, v75
    v_cvt_pk_bf16_f32 v72, v76, v77
    v_cvt_pk_bf16_f32 v73, v78, v79
    v_cvt_pk_bf16_f32 v74, v80, v81
    v_cvt_pk_bf16_f32 v75, v82, v83
    s_cbranch_scc1 L_st3a
    buffer_store_dwordx4 v[68:71], v6, s[12:15], s28 offen offset:1024 sc1
    buffer_store_dwordx4 v[72:75], v6, s[12:15], s28 offen offset:1280 sc1
    s_branch L_st3b
L_st3a:
    buffer_store_dwordx4 v[68:71], v6, s[12:15], s28 offen offset:1024
    buffer_store_dwordx4 v[72:75], v6, s[12:15], s28 offen offset:1280
L_st3b:

    v_mov_b32 v3, 0
    s_waitcnt vmcnt(0)
    s_mov_b64 exec, 1

    s_cbranch_scc1 L_st5a
    buffer_store_dwordx2 v[112:113], v3, s[12:15], s29 offen sc1
    s_nop 0
    s_branch L_st5b
L_st5a:
    buffer_store_dwordx2 v[112:113], v3, s[12:15], s29 offen
    s_nop 0
L_st5b:

    s_mov_b64 exec, -1
L_p2:
    s_setprio 0
    v_mov_b32 v3, 68608
    ds_read_b96 v[4:6], v3
    v_and_b32 v2, 63, v0
    v_lshlrev_b32 v3, 3, v2
    v_lshlrev_b32 v2, 4, v2
    s_and_b32 s4, s16, 7
    s_lshr_b32 s5, s16, 3
    s_and_b32 s6, s2, 7
    s_lshl_b32 s6, s6, 2
    s_bfe_u32 s18, s2, 0x20003
    s_add_u32 s6, s6, s18
    s_lshr_b32 s7, s2, 5
    s_mov_b32 s10, 0x0000ffff
    s_mov_b32 s11, 0x0000ffff
    s_lshl_b32 s8, s7, 3
    s_add_u32 s8, s8, s4
    s_lshl_b32 s21, s6, 16
    s_lshl_b32 s18, s8, 10
    s_add_u32 s21, s21, s18
    s_lshl_b32 s20, s5, 16
    s_lshl_b32 s18, s4, 10
    s_add_u32 s18, s18, s20
    s_lshl_b32 s19, s6, 17
    s_add_u32 s19, s19, 2097152
    s_add_u32 s19, s19, s18
    v_add_u32 v1, s20, v2
    s_lshl_b32 s46, s8, 15
    s_lshl_b32 s22, s6, 10
    s_add_u32 s46, s46, s22
    s_add_u32 s46, s46, 6291456
    s_waitcnt lgkmcnt(0)
    v_readfirstlane_b32 s86, v4
    v_readfirstlane_b32 s87, v5
    v_readfirstlane_b32 s22, v6
    s_or_b32 s22, s22, s91
    s_cmp_lg_u32 s22, 2
    s_cbranch_scc1 L_norestart
    s_mov_b32 s2, s3
    s_mov_b32 s91, 1
    s_waitcnt vmcnt(0)
    s_barrier
    s_branch L_start
L_norestart:
    s_cmp_lg_u32 s16, 15
    s_cbranch_scc1 L_p2_nopoll
    s_lshr_b32 s22, s6, 1
    s_lshl_b32 s22, s22, 10
    s_add_u32 s22, s22, 10485760

    s_mov_b32 s90, 0
L_pf1:
    buffer_load_dwordx2 v[4:5], v3, s[12:15], s22 offen offset:0 sc1
    buffer_load_dwordx2 v[6:7], v3, s[12:15], s22 offen offset:512 sc1
L_pfc1:
    s_add_u32 s90, s90, 1
    s_waitcnt vmcnt(0)
    v_cmp_ne_u64 vcc, s[86:87], v[4:5]

    v_cmp_ne_u64 s[92:93], s[86:87], v[6:7]
    s_or_b64 vcc, vcc, s[92:93]
    s_cmp_ge_u32 s90, 200000
    s_cbranch_scc1 L_pfd1
    s_cbranch_vccz L_pfd1

    s_branch L_pf1

L_pfd1:
L_p2_nopoll:
    v_and_b32 v3, 27, v0
    v_mov_b32 v17, 0x3f803f80
    v_cmp_eq_u32 vcc, 16, v3
    s_nop 1
    v_cndmask_b32 v16, 0, v17, vcc

    v_mov_b32 v17, v16
    v_mov_b32 v18, v16
    v_mov_b32 v19, v16
    v_mov_b32 v20, v16
    v_mov_b32 v21, v16
    v_mov_b32 v22, v16
    v_mov_b32 v23, v16
    v_mov_b32 v24, v16
    v_mov_b32 v25, v16
    v_mov_b32 v26, v16
    v_mov_b32 v27, v16
    v_mov_b32 v28, v16
    v_mov_b32 v29, v16
    v_mov_b32 v30, v16
    v_mov_b32 v31, v16
    v_lshrrev_b32 v108, 7, v2
    v_bfe_u32 v109, v2, 4, 3
    v_mul_u32_u24 v102, 3584, v108
    v_lshl_add_u32 v102, v109, 4, v102
    v_lshlrev_b32 v109, 14, v109
    v_lshl_add_u32 v100, v108, 4, v109
    v_lshrrev_b32 v109, 8, v2
    v_and_b32 v103, 0xf0, v2
    v_lshl_add_u32 v103, v109, 10, v103
    v_bfe_u32 v110, v2, 5, 3
    v_mul_u32_u24 v110, 57344, v110
    v_lshl_add_u32 v110, v109, 5, v110
    v_and_b32 v101, 16, v2
    v_add_u32 v101, v101, v110
    v_bfe_u32 v124, v2, 8, 1
    v_lshlrev_b32 v124, 6, v124
    v_and_b32 v125, 0x70, v2
    v_xor_b32 v124, v124, v125
    v_lshl_add_u32 v124, v108, 10, v124
    v_lshlrev_b32 v109, 4, v108
    v_xor_b32 v125, v125, v109
    v_lshl_add_u32 v125, v108, 10, v125
    v_mov_b32 v104, -1
    v_mov_b32 v105, -1
    v_mov_b32 v106, -1
    v_mov_b32 v107, -1

    v_mov_b32 v40, 0
    v_mov_b32 v41, 0
    v_mov_b32 v42, 0
    v_mov_b32 v43, 0
    v_mov_b32 v44, 0
    v_mov_b32 v45, 0
    v_mov_b32 v46, 0
    v_mov_b32 v47, 0
    v_mov_b32 v80, 0
    v_mov_b32 v81, 0
    v_mov_b32 v82, 0
    v_mov_b32 v83, 0
    v_mov_b32 v84, 0
    v_mov_b32 v85, 0
    v_mov_b32 v86, 0
    v_mov_b32 v87, 0
    v_mov_b32 v88, 0
    v_mov_b32 v89, 0
    v_mov_b32 v90, 0
    v_mov_b32 v91, 0
    v_mov_b32 v92, 0
    v_mov_b32 v93, 0
    v_mov_b32 v94, 0
    v_mov_b32 v95, 0
    s_mov_b32 m0, s18
    s_add_u32 s22, s18, 8192
    s_add_u32 s23, s19, 8192
    s_mov_b32 s9, 0
    s_mov_b32 s17, 3
    v_mov_b32 v120, 136192
    v_mov_b32 v121, 1
    v_mov_b32 v122, 0
    v_mov_b32 v123, 0
    s_barrier
    ds_write_b64 v120, v[122:123]

    buffer_load_dwordx4 v2, s[12:15], s19 offen lds
    buffer_load_dwordx4 v[4:7], v2, s[12:15], s21 offen
    s_mov_b32 m0, s22
    s_setprio 3
    buffer_load_dwordx4 v2, s[12:15], s23 offen lds
    s_waitcnt vmcnt(0) lgkmcnt(0)
    s_barrier

    ds_read_b128 v[8:11], v1
    ds_read_b128 v[12:15], v1 offset:2048
    s_cmp_eq_u32 s5, 0
    s_cbranch_scc1 L_p2_noload
    s_sub_u32 s18, s18, 49152
    s_sub_u32 s19, s19, 49152

    s_mov_b32 m0, s18
    s_add_u32 s22, s18, 65536
    buffer_load_dwordx4 v2, s[12:15], s19 offen lds
    s_add_u32 s23, s19, 65536
    s_mov_b32 m0, s22
    s_add_u32 s18, s18, 8192
    buffer_load_dwordx4 v2, s[12:15], s23 offen lds
    s_add_u32 s19, s19, 8192

    s_mov_b32 m0, s18
    s_add_u32 s22, s18, 65536
    buffer_load_dwordx4 v2, s[12:15], s19 offen lds
    s_add_u32 s23, s19, 65536
    s_mov_b32 m0, s22
    s_add_u32 s18, s18, 8192
    buffer_load_dwordx4 v2, s[12:15], s23 offen lds
    s_add_u32 s19, s19, 8192

    s_mov_b32 m0, s18
    s_add_u32 s22, s18, 65536
    buffer_load_dwordx4 v2, s[12:15], s19 offen lds
    s_add_u32 s23, s19, 65536
    s_mov_b32 m0, s22
    s_add_u32 s18, s18, 8192
    buffer_load_dwordx4 v2, s[12:15], s23 offen lds
    s_add_u32 s19, s19, 8192

    s_mov_b32 m0, s18
    s_add_u32 s22, s18, 65536
    buffer_load_dwordx4 v2, s[12:15], s19 offen lds
    s_add_u32 s23, s19, 65536
    s_mov_b32 m0, s22
    s_add_u32 s18, s18, 8192
    buffer_load_dwordx4 v2, s[12:15], s23 offen lds
    s_add_u32 s19, s19, 8192

    s_mov_b32 m0, s18
    s_add_u32 s22, s18, 65536
    buffer_load_dwordx4 v2, s[12:15], s19 offen lds
    s_add_u32 s23, s19, 65536
    s_mov_b32 m0, s22
    s_add_u32 s18, s18, 8192
    buffer_load_dwordx4 v2, s[12:15], s23 offen lds
    s_add_u32 s19, s19, 8192

    s_mov_b32 m0, s18
    s_add_u32 s22, s18, 65536
    buffer_load_dwordx4 v2, s[12:15], s19 offen lds
    s_add_u32 s23, s19, 65536
    s_mov_b32 m0, s22
    s_add_u32 s18, s18, 8192
    buffer_load_dwordx4 v2, s[12:15], s23 offen lds
    s_add_u32 s19, s19, 8192

    s_waitcnt vmcnt(0)
    s_mov_b64 exec, 1
    ds_add_u32 v120, v121
    s_mov_b64 exec, -1
    s_waitcnt lgkmcnt(0)

L_p2_noload:
    s_waitcnt lgkmcnt(1)
    v_mfma_f32_32x32x16_bf16 v[48:63], v[8:11], v[4:7], 0
    s_nop 7

L_p2_loop:
    s_waitcnt lgkmcnt(0)
    v_mfma_f32_32x32x16_bf16 v[64:79], v[12:15], v[4:7], 0
    ds_read_b128 v[8:11], v1 offset:4096
    s_mov_b64 exec, s[10:11]
    ds_read_b128 v[16:19], v1 offset:1024
    ds_read_b128 v[20:23], v1 offset:1280
    s_mov_b64 exec, -1

    v_exp_f32 v48, v48
    v_exp_f32 v49, v49
    v_exp_f32 v50, v50
    v_exp_f32 v51, v51
    v_cvt_pk_bf16_f32 v32, v48, v49
    v_exp_f32 v52, v52
    v_exp_f32 v53, v53
    v_cvt_pk_bf16_f32 v33, v50, v51
    v_mfma_f32_32x32x16_bf16 v[80:95], v[24:27], v[40:43], v[80:95]
    v_exp_f32 v54, v54
    v_exp_f32 v55, v55
    v_cvt_pk_bf16_f32 v34, v52, v53
    v_exp_f32 v56, v56
    v_exp_f32 v57, v57
    v_cvt_pk_bf16_f32 v35, v54, v55
    v_exp_f32 v58, v58
    v_exp_f32 v59, v59
    v_cvt_pk_bf16_f32 v36, v56, v57
    v_mfma_f32_32x32x16_bf16 v[80:95], v[28:31], v[44:47], v[80:95]
    v_exp_f32 v60, v60
    v_exp_f32 v61, v61
    v_cvt_pk_bf16_f32 v37, v58, v59
    v_exp_f32 v62, v62
    v_exp_f32 v63, v63
    v_cvt_pk_bf16_f32 v38, v60, v61
    s_add_u32 s9, s9, 1
    v_cvt_pk_bf16_f32 v39, v62, v63
    s_waitcnt lgkmcnt(0)
    v_mfma_f32_32x32x16_bf16 v[48:63], v[8:11], v[4:7], 0
    ds_read_b128 v[12:15], v1 offset:6144
    s_mov_b64 exec, s[10:11]
    ds_read_b128 v[24:27], v1 offset:3072
    ds_read_b128 v[28:31], v1 offset:3328
    s_mov_b64 exec, -1

    v_exp_f32 v64, v64
    v_exp_f32 v65, v65
    v_exp_f32 v66, v66
    v_exp_f32 v67, v67
    v_cvt_pk_bf16_f32 v40, v64, v65
    v_exp_f32 v68, v68
    v_exp_f32 v69, v69
    v_cvt_pk_bf16_f32 v41, v66, v67
    v_mfma_f32_32x32x16_bf16 v[80:95], v[16:19], v[32:35], v[80:95]
    v_exp_f32 v70, v70
    v_exp_f32 v71, v71
    v_cvt_pk_bf16_f32 v42, v68, v69
    v_exp_f32 v72, v72
    v_exp_f32 v73, v73
    v_cvt_pk_bf16_f32 v43, v70, v71
    v_exp_f32 v74, v74
    v_exp_f32 v75, v75
    v_cvt_pk_bf16_f32 v44, v72, v73
    v_mfma_f32_32x32x16_bf16 v[80:95], v[20:23], v[36:39], v[80:95]
    v_exp_f32 v76, v76
    v_exp_f32 v77, v77
    v_cvt_pk_bf16_f32 v45, v74, v75
    v_exp_f32 v78, v78
    v_exp_f32 v79, v79
    v_cvt_pk_bf16_f32 v46, v76, v77
    v_add_u32 v1, 4096, v1
    v_cvt_pk_bf16_f32 v47, v78, v79
    s_cmp_lt_u32 s9, s17
    s_cbranch_scc1 L_p2_loop

    s_cmp_lg_u32 s9, 3
    s_cbranch_scc1 L_p2_ph0

L_spa:
    ds_read_b32 v122, v120 offset:0
    s_waitcnt lgkmcnt(0)
    v_readfirstlane_b32 s22, v122
    s_cmp_lt_u32 s22, 8
    s_cbranch_scc1 L_spa

    s_mov_b32 s40, s68
    s_mov_b32 s41, s69
    s_mov_b32 s42, 0x80000
    s_mov_b32 s43, 0x00020000
    s_lshr_b32 s22, s2, 3
    s_lshl_b32 s22, s22, 14
    s_lshl_b32 s23, s16, 10
    s_add_u32 s22, s22, s23
    buffer_load_dwordx4 v[116:119], v2, s[40:43], s22 offen
    s_cmp_lt_u32 s16, 8
    s_cbranch_scc1 L_norst
    buffer_store_dwordx4 v[104:107], v2, s[12:15], s46 offen sc1
L_norst:
    s_cmp_lg_u32 s16, 7
    s_cbranch_scc1 L_nowb
    s_cmp_ge_u32 s2, 8
    s_cbranch_scc1 L_nowb
    buffer_wbl2 sc1
L_nowb:
    s_cmp_ge_u32 s16, 7
    s_cbranch_scc1 L_nopl
    s_bitcmp1_b32 s2, 1
    s_cselect_b32 s32, s76, s74
    s_cselect_b32 s33, s77, s75
    s_mov_b32 s34, 1835008
    s_mov_b32 s35, 0x00020000
    s_mov_b32 s36, s78
    s_mov_b32 s37, s79
    s_mov_b32 s38, 1835008
    s_mov_b32 s39, 0x00020000
    s_lshr_b32 s22, s2, 2
    s_and_b32 s23, s2, 1
    s_mul_i32 s23, s23, 14
    s_lshl_b32 s24, s16, 1
    s_add_u32 s23, s23, s24
    s_mul_i32 s24, s22, 28672
    s_lshl_b32 s25, s23, 7
    s_add_u32 s24, s24, s25
    buffer_load_dwordx4 v[104:107], v102, s[32:35], s24 offen
    buffer_load_dwordx4 v[108:111], v102, s[32:35], s24 offen offset:128
    s_lshl_b32 s44, s23, 17
    s_lshl_b32 s22, s22, 7
    s_add_u32 s44, s44, s22
    s_bfe_u32 s22, s2, 0x10001
    s_lshl_b32 s22, s22, 13
    s_add_u32 s44, s44, s22
    s_add_u32 s44, s44, 16777216
    s_mul_i32 s22, s2, 7
    s_add_u32 s22, s22, s16
    s_lshr_b32 s23, s22, 2
    s_and_b32 s22, s22, 3
    s_lshl_b32 s24, s23, 12
    s_lshl_b32 s25, s22, 8
    s_add_u32 s24, s24, s25
    buffer_load_dwordx4 v[112:115], v103, s[36:39], s24 offen
    s_mul_i32 s45, s22, 458752
    s_lshl_b32 s23, s23, 7
    s_add_u32 s45, s45, s23
    s_add_u32 s45, s45, 20971520
L_nopl:

    s_mov_b32 s17, 10
    s_branch L_p2_loop

L_p2_ph0:
    s_cmp_lg_u32 s9, 10
    s_cbranch_scc1 L_p2_ph1
    s_setprio 2
    s_waitcnt lgkmcnt(0)
    s_mov_b64 exec, 1
    ds_add_u32 v120, v121 offset:4
    s_mov_b64 exec, -1

    s_waitcnt vmcnt(0)
    s_cmp_ge_u32 s16, 7
    s_cbranch_scc1 L_nops
    s_add_u32 s22, s44, 131072
    buffer_store_dwordx4 v[104:107], v100, s[12:15], s44 offen sc1
    buffer_store_dwordx4 v[108:111], v100, s[12:15], s22 offen sc1
    buffer_store_dwordx4 v[112:115], v101, s[12:15], s45 offen sc1
L_nops:

    s_mov_b32 s17, 13
    s_branch L_p2_loop

L_p2_ph1:
    s_cmp_lg_u32 s9, 13
    s_cbranch_scc1 L_p2_ph2
    s_setprio 1

L_spb:
    ds_read_b32 v122, v120 offset:4
    s_waitcnt lgkmcnt(0)
    v_readfirstlane_b32 s22, v122
    s_cmp_lt_u32 s22, 16
    s_cbranch_scc1 L_spb
    s_mov_b32 s40, s68
    s_mov_b32 s41, s69
    s_mov_b32 s42, 0x80000
    s_mov_b32 s43, 0x00020000
    s_bfe_u32 s22, s2, 0x30003
    s_lshl_b32 s22, s22, 7
    s_lshl_b32 s23, s16, 15
    s_add_u32 s23, s23, s22
    s_and_b32 s24, s16, 7
    s_lshl_b32 s24, s24, 12
    s_lshr_b32 s25, s16, 3
    s_lshl_b32 s25, s25, 16
    s_add_u32 s24, s24, s25
    s_mov_b32 m0, s24
    s_add_u32 s25, s23, 7168
    buffer_load_dwordx4 v124, s[40:43], s23 offen lds
    buffer_load_dwordx4 v124, s[40:43], s25 offen offset:1024 lds
    s_add_u32 s25, s23, 14336
    s_add_u32 s26, s23, 21504
    buffer_load_dwordx4 v124, s[40:43], s25 offen offset:2048 lds
    buffer_load_dwordx4 v124, s[40:43], s26 offen offset:3072 lds
    s_cmp_ge_u32 s16, 8
    s_cbranch_scc1 L_nox
    s_mov_b32 s32, s64
    s_mov_b32 s33, s65
    s_mov_b32 s34, 0x200000
    s_mov_b32 s35, 0x00020000
    s_and_b32 s23, s2, 7
    s_lshl_b32 s23, s23, 2
    s_lshr_b32 s24, s2, 6
    s_add_u32 s23, s23, s24
    s_lshl_b32 s23, s23, 16
    s_add_u32 s23, s23, s22
    s_lshl_b32 s24, s16, 13
    s_add_u32 s23, s23, s24
    s_lshl_b32 s24, s16, 10
    s_add_u32 m0, s24, 32768
    s_nop 0
    buffer_load_dwordx4 v125, s[32:35], s23 offen lds
    s_cmp_lg_u32 s16, 0
    s_cbranch_scc1 L_nox
    s_mov_b32 s32, s80
    s_mov_b32 s33, s81
    v_lshlrev_b32 v103, 6, v2
    buffer_load_dword v118, v103, s[32:35], s23 offen nt
L_nox:

    s_mov_b32 s17, 15
    s_branch L_p2_loop

L_p2_ph2:
    s_cmp_lg_u32 s9, 15
    s_cbranch_scc1 L_p2_ph3
    s_setprio 0
    s_mov_b32 s17, 16
    s_branch L_p2_loop

L_p2_ph3:
    s_waitcnt lgkmcnt(0)
    v_mfma_f32_32x32x16_bf16 v[80:95], v[24:27], v[40:43], v[80:95]
    v_mfma_f32_32x32x16_bf16 v[80:95], v[28:31], v[44:47], v[80:95]

    s_mul_i32 s18, s4, 2304
    s_add_u32 s18, s18, 145408
    v_add_u32 v1, s18, v2
    v_lshrrev_b32 v3, 2, v2
    v_add_u32 v3, s18, v3
    s_lshl_b32 s47, s8, 8
    s_lshl_b32 s19, s6, 3
    s_add_u32 s47, s47, s19
    s_add_u32 s47, s47, 10502144
    s_cmp_eq_u32 s5, 0
    s_cbranch_scc0 L_p2_fin
    s_nop 3
    ds_write_b128 v1, v[80:83]
    ds_write_b128 v1, v[84:87] offset:1024
    ds_write_b32 v3, v88 offset:2048
    s_waitcnt vmcnt(0) lgkmcnt(0)
    s_barrier
    s_branch L_p3

L_p2_fin:
    v_mov_b32 v100, s86
    v_mov_b32 v101, s87
    v_mov_b32 v102, 0
    s_waitcnt vmcnt(0)
    s_barrier
    ds_read_b128 v[8:11], v1
    ds_read_b128 v[12:15], v1 offset:1024
    ds_read_b32 v16, v3 offset:2048
    s_cmp_lg_u32 s4, 0
    s_cbranch_scc1 L_p2_nofw
    s_lshl_b32 s18, s2, 3
    s_add_u32 s18, s18, 10534912
    s_mov_b64 exec, 1
    buffer_store_dwordx2 v[100:101], v102, s[12:15], s18 offen sc1
    s_mov_b64 exec, -1
L_p2_nofw:
    s_mov_b32 s18, 0x21800000
    s_mov_b32 s19, 0x5d800000
    s_mov_b32 s20, 0x7f000000
    s_waitcnt lgkmcnt(0)

    v_add_f32 v8, v8, v80
    v_add_f32 v9, v9, v81
    v_add_f32 v10, v10, v82
    v_add_f32 v11, v11, v83
    v_add_f32 v12, v12, v84
    v_add_f32 v13, v13, v85
    v_add_f32 v14, v14, v86
    v_add_f32 v15, v15, v87
    v_add_f32 v16, v16, v88
    v_rcp_f32 v17, v16
    v_add_f32 v3, |v8|, |v9|
    v_add_f32 v96, |v10|, |v11|
    v_add_f32 v97, |v12|, |v13|
    v_add_f32 v98, |v14|, |v15|
    v_cmp_le_f32 s[22:23], s18, v16
    v_add_f32 v3, v3, v96
    v_add_f32 v97, v97, v98
    v_cmp_ge_f32 s[24:25], s19, v16
    v_add_f32 v3, v3, v97
    v_cmp_gt_f32 s[26:27], s20, v3
    s_and_b64 s[22:23], s[22:23], s[24:25]
    s_and_b64 s[22:23], s[22:23], s[26:27]
    s_cmp_eq_u64 s[22:23], -1
    s_cbranch_scc0 L_p2_slow

L_p2_store:
    v_mul_f32 v8, v8, v17
    v_mul_f32 v9, v9, v17
    v_mul_f32 v10, v10, v17
    v_mul_f32 v11, v11, v17
    v_mul_f32 v12, v12, v17
    v_mul_f32 v13, v13, v17
    v_mul_f32 v14, v14, v17
    v_mul_f32 v15, v15, v17
    v_cvt_pk_bf16_f32 v20, v8, v9
    v_cvt_pk_bf16_f32 v21, v10, v11
    v_cvt_pk_bf16_f32 v22, v12, v13
    v_cvt_pk_bf16_f32 v23, v14, v15
    v_min_u32 v20, 0xfffffffe, v20
    v_min_u32 v21, 0xfffffffe, v21
    v_min_u32 v22, 0xfffffffe, v22
    v_min_u32 v23, 0xfffffffe, v23
    buffer_store_dwordx4 v[20:23], v2, s[12:15], s46 offen sc1

    s_mov_b64 exec, 1
    buffer_store_dwordx2 v[100:101], v102, s[12:15], s47 offen sc1
    s_mov_b64 exec, -1

    s_cmp_lt_u32 s16, 12
    s_cbranch_scc1 L_p3

    s_endpgm
L_p2_slow:
    s_lshl_b32 s19, s6, 17
    s_add_u32 s19, s19, 2097152
    v_mov_b32 v96, 0xff800000
    s_mov_b32 s9, 0

L_p2_s1:
    s_add_u32 s20, s19, s9
    buffer_load_dwordx4 v[8:11], v2, s[12:15], s20 offen
    s_waitcnt vmcnt(0)
    v_mfma_f32_32x32x16_bf16 v[48:63], v[8:11], v[4:7], 0
    s_nop 15

    v_max3_f32 v96, v96, v48, v49
    v_max3_f32 v96, v96, v50, v51
    v_max3_f32 v96, v96, v52, v53
    v_max3_f32 v96, v96, v54, v55
    v_max3_f32 v96, v96, v56, v57
    v_max3_f32 v96, v96, v58, v59
    v_max3_f32 v96, v96, v60, v61
    v_max3_f32 v96, v96, v62, v63
    s_add_u32 s9, s9, 2048
    s_cmp_lt_u32 s9, 131072
    s_cbranch_scc1 L_p2_s1
    v_mov_b32 v97, v96
    s_nop 1
    v_permlane32_swap_b32 v96, v97
    s_nop 1
    v_max_f32 v96, v96, v97

    v_mov_b32 v16, 0x3f803f80
    v_mov_b32 v17, 0x3f803f80
    v_mov_b32 v18, 0x3f803f80
    v_mov_b32 v19, 0x3f803f80
    v_mov_b32 v20, 0x3f803f80
    v_mov_b32 v21, 0x3f803f80
    v_mov_b32 v22, 0x3f803f80
    v_mov_b32 v23, 0x3f803f80
    v_mov_b32 v80, 0
    v_mov_b32 v81, 0
    v_mov_b32 v82, 0
    v_mov_b32 v83, 0
    v_mov_b32 v84, 0
    v_mov_b32 v85, 0
    v_mov_b32 v86, 0
    v_mov_b32 v87, 0
    v_mov_b32 v88, 0
    v_mov_b32 v89, 0
    v_mov_b32 v90, 0
    v_mov_b32 v91, 0
    v_mov_b32 v92, 0
    v_mov_b32 v93, 0
    v_mov_b32 v94, 0
    v_mov_b32 v95, 0
    s_mov_b32 s9, 0
L_p2_s2:
    s_add_u32 s20, s19, s9
    buffer_load_dwordx4 v[8:11], v2, s[12:15], s20 offen
    s_mov_b64 exec, s[10:11]
    buffer_load_dwordx4 v[16:19], v2, s[12:15], s20 offen offset:1024
    buffer_load_dwordx4 v[20:23], v2, s[12:15], s20 offen offset:1280
    s_mov_b64 exec, -1
    s_waitcnt vmcnt(0)
    v_mfma_f32_32x32x16_bf16 v[48:63], v[8:11], v[4:7], 0
    s_nop 15

    v_sub_f32 v48, v48, v96
    v_sub_f32 v49, v49, v96
    v_sub_f32 v50, v50, v96
    v_sub_f32 v51, v51, v96
    v_sub_f32 v52, v52, v96
    v_sub_f32 v53, v53, v96
    v_sub_f32 v54, v54, v96
    v_sub_f32 v55, v55, v96
    v_sub_f32 v56, v56, v96
    v_sub_f32 v57, v57, v96
    v_sub_f32 v58, v58, v96
    v_sub_f32 v59, v59, v96
    v_sub_f32 v60, v60, v96
    v_sub_f32 v61, v61, v96
    v_sub_f32 v62, v62, v96
    v_sub_f32 v63, v63, v96
    v_exp_f32 v48, v48
    v_exp_f32 v49, v49
    v_exp_f32 v50, v50
    v_exp_f32 v51, v51
    v_exp_f32 v52, v52
    v_exp_f32 v53, v53
    v_exp_f32 v54, v54
    v_exp_f32 v55, v55
    v_exp_f32 v56, v56
    v_exp_f32 v57, v57
    v_exp_f32 v58, v58
    v_exp_f32 v59, v59
    v_exp_f32 v60, v60
    v_exp_f32 v61, v61
    v_exp_f32 v62, v62
    v_exp_f32 v63, v63
    s_nop 0
    v_cvt_pk_bf16_f32 v32, v48, v49
    v_cvt_pk_bf16_f32 v33, v50, v51
    v_cvt_pk_bf16_f32 v34, v52, v53
    v_cvt_pk_bf16_f32 v35, v54, v55
    v_cvt_pk_bf16_f32 v36, v56, v57
    v_cvt_pk_bf16_f32 v37, v58, v59
    v_cvt_pk_bf16_f32 v38, v60, v61
    v_cvt_pk_bf16_f32 v39, v62, v63
    s_nop 1
    v_mfma_f32_32x32x16_bf16 v[80:95], v[16:19], v[32:35], v[80:95]
    v_mfma_f32_32x32x16_bf16 v[80:95], v[20:23], v[36:39], v[80:95]
    s_add_u32 s9, s9, 2048
    s_cmp_lt_u32 s9, 131072
    s_cbranch_scc1 L_p2_s2
    s_nop 15

    v_mov_b32 v8, v80
    v_mov_b32 v9, v81
    v_mov_b32 v10, v82
    v_mov_b32 v11, v83
    v_mov_b32 v12, v84
    v_mov_b32 v13, v85
    v_mov_b32 v14, v86
    v_mov_b32 v15, v87
    v_mov_b32 v16, v88
    v_rcp_f32 v17, v16
    s_nop 0
    s_branch L_p2_store

L_p3:
    v_and_b32 v1, 63, v0
    s_and_b32 s23, s2, 7
    s_lshr_b32 s24, s2, 3
    s_and_b32 s20, s24, 7
    s_lshr_b32 s25, s24, 3
    s_lshl_b32 s19, s23, 2
    s_add_u32 s19, s19, s25
    s_add_u32 s21, s20, s25
    s_and_b32 s21, s21, 3
    s_and_b32 s17, s16, 1
    s_bfe_u32 s18, s16, 0x10001
    s_mov_b32 s22, 0
    s_mov_b32 s4, s64
    s_mov_b32 s5, s65
    s_mov_b32 s6, 0x200000
    s_mov_b32 s7, 0x00020000
    s_mov_b32 s8, s68
    s_mov_b32 s9, s69
    s_mov_b32 s10, 0x80000
    s_mov_b32 s11, 0x00020000
    s_mov_b32 s32, s80
    s_mov_b32 s33, s81
    s_mov_b32 s34, 0x200000
    s_mov_b32 s35, 0x00020000
    s_mov_b32 s36, s72
    s_mov_b32 s37, s73
    s_mov_b32 s38, 1024
    s_mov_b32 s39, 0x00020000
    s_bitcmp0_b32 s16, 2
    s_cbranch_scc1 L_p3_mfma

    s_and_b32 s31, s16, 3
    v_lshlrev_b32 v8, 4, v1
    s_lshl_b32 s27, s19, 16
    s_add_u32 s27, s27, 6291456
    s_lshl_b32 s28, s31, 11

    v_lshlrev_b32 v6, 3, v1
    s_lshl_b32 s23, s19, 9
    s_add_u32 s23, s23, 10502144

    s_cmp_eq_u32 s31, 0
    s_cbranch_scc1 L_p3_poll
    buffer_load_dwordx4 v[16:19], v8, s[36:39], 0 offen
    s_mov_b32 s30, 0xffff0000
    s_waitcnt vmcnt(0)

    v_lshlrev_b32 v20, 16, v16
    v_and_b32 v16, s30, v16
    v_lshlrev_b32 v21, 16, v17
    v_and_b32 v17, s30, v17
    v_lshlrev_b32 v22, 16, v18
    v_and_b32 v18, s30, v18
    v_lshlrev_b32 v23, 16, v19
    v_and_b32 v19, s30, v19
    v_add_f32 v16, v16, v20
    v_add_f32 v17, v17, v21
    v_add_f32 v18, v18, v22
    v_add_f32 v19, v19, v23
    v_add_f32 v16, v16, v17
    v_add_f32 v18, v18, v19
    v_add_f32 v16, v16, v18

    s_nop 1
    v_add_f32_dpp v16, v16, v16 quad_perm:[1,0,3,2] row_mask:0xf bank_mask:0xf
    s_nop 1
    v_add_f32_dpp v16, v16, v16 quad_perm:[2,3,0,1] row_mask:0xf bank_mask:0xf
    s_nop 1
    v_add_f32_dpp v16, v16, v16 row_half_mirror row_mask:0xf bank_mask:0xf
    s_nop 1
    v_add_f32_dpp v16, v16, v16 row_mirror row_mask:0xf bank_mask:0xf
    s_nop 1
    v_readlane_b32 s25, v16, 0
    v_readlane_b32 s26, v16, 16
    v_readlane_b32 s27, v16, 32
    v_readlane_b32 s28, v16, 48
    s_nop 1
    v_mov_b32 v10, s25
    v_add_f32 v10, s26, v10
    v_add_f32 v10, s27, v10
    v_add_f32 v10, s28, v10
    s_lshl_b32 s27, s19, 16
    s_add_u32 s27, s27, 6291456
    s_lshl_b32 s28, s31, 11
    s_branch L_pfd2
L_p3_poll:

    s_mov_b32 s90, 0
L_pf2:
    buffer_load_dwordx2 v[12:13], v6, s[12:15], s23 offen offset:0 sc1
L_pfc2:
    s_add_u32 s90, s90, 1
    s_waitcnt vmcnt(0)
    v_cmp_ne_u64 vcc, s[86:87], v[12:13]

    s_cmp_ge_u32 s90, 200000
    s_cbranch_scc1 L_pfd2
    s_cbranch_vccz L_pfd2

    s_branch L_pf2

L_pfd2:
    s_barrier

    s_mov_b32 s26, s21
    s_lshl_b32 s23, s21, 13
    s_add_u32 s23, s23, s28
    s_add_u32 s24, s23, s27
    s_add_u32 m0, s23, 98304
    s_add_u32 s25, s24, 32768
    buffer_load_dwordx4 v8, s[12:15], s24 offen lds
    buffer_load_dwordx4 v8, s[12:15], s24 offen offset:1024 lds
    s_add_u32 m0, s23, 131072
    s_nop 0
    buffer_load_dwordx4 v8, s[12:15], s25 offen lds
    buffer_load_dwordx4 v8, s[12:15], s25 offen offset:1024 lds

    s_add_u32 s21, s21, 1
    s_and_b32 s21, s21, 3
    s_lshl_b32 s23, s21, 13
    s_add_u32 s23, s23, s28
    s_add_u32 s24, s23, s27
    s_add_u32 m0, s23, 98304
    s_add_u32 s25, s24, 32768
    buffer_load_dwordx4 v8, s[12:15], s24 offen lds
    buffer_load_dwordx4 v8, s[12:15], s24 offen offset:1024 lds
    s_add_u32 m0, s23, 131072
    s_nop 0
    buffer_load_dwordx4 v8, s[12:15], s25 offen lds
    buffer_load_dwordx4 v8, s[12:15], s25 offen offset:1024 lds

    s_add_u32 s21, s21, 1
    s_and_b32 s21, s21, 3
    s_lshl_b32 s23, s21, 13
    s_add_u32 s23, s23, s28
    s_add_u32 s24, s23, s27
    s_add_u32 m0, s23, 98304
    s_add_u32 s25, s24, 32768
    buffer_load_dwordx4 v8, s[12:15], s24 offen lds
    buffer_load_dwordx4 v8, s[12:15], s24 offen offset:1024 lds
    s_add_u32 m0, s23, 131072
    s_nop 0
    buffer_load_dwordx4 v8, s[12:15], s25 offen lds
    buffer_load_dwordx4 v8, s[12:15], s25 offen offset:1024 lds

    s_add_u32 s21, s21, 1
    s_and_b32 s21, s21, 3
    s_lshl_b32 s23, s21, 13
    s_add_u32 s23, s23, s28
    s_add_u32 s24, s23, s27
    s_add_u32 m0, s23, 98304
    s_add_u32 s25, s24, 32768
    buffer_load_dwordx4 v8, s[12:15], s24 offen lds
    buffer_load_dwordx4 v8, s[12:15], s24 offen offset:1024 lds
    s_add_u32 m0, s23, 131072
    s_nop 0
    buffer_load_dwordx4 v8, s[12:15], s25 offen lds
    buffer_load_dwordx4 v8, s[12:15], s25 offen offset:1024 lds

    s_add_u32 s21, s21, 1
    s_and_b32 s21, s21, 3

    s_lshl_b32 s23, s26, 13
    s_add_u32 s23, s23, s28
    s_add_u32 s23, s23, 98304
    v_add_u32 v7, s23, v8
    s_mov_b32 s90, 0
    s_waitcnt vmcnt(12)
L_ov0:
    ds_read_b128 v[16:19], v7
    ds_read_b128 v[20:23], v7 offset:1024
    ds_read_b128 v[24:27], v7 offset:32768
    ds_read_b128 v[28:31], v7 offset:33792
    s_waitcnt lgkmcnt(2)
    v_max3_u32 v16, v16, v17, v18
    v_max3_u32 v20, v20, v21, v22
    v_max3_u32 v16, v16, v19, v23
    s_waitcnt lgkmcnt(0)
    v_max3_u32 v24, v24, v25, v26
    v_max3_u32 v28, v28, v29, v30
    v_max3_u32 v24, v24, v27, v31
    v_max3_u32 v16, v16, v20, v24
    v_max_u32 v16, v16, v28
    v_cmp_eq_u32 vcc, -1, v16
    s_add_u32 s90, s90, 1
    s_cbranch_vccz L_ok0
    s_cmp_ge_u32 s90, 100000
    s_cbranch_scc1 L_ok0

    s_lshl_b32 s23, s26, 13
    s_add_u32 s23, s23, s28
    s_add_u32 s24, s23, s27
    s_add_u32 m0, s23, 98304
    s_add_u32 s25, s24, 32768
    buffer_load_dwordx4 v8, s[12:15], s24 offen sc1 lds
    buffer_load_dwordx4 v8, s[12:15], s24 offen offset:1024 sc1 lds
    s_add_u32 m0, s23, 131072
    s_nop 0
    buffer_load_dwordx4 v8, s[12:15], s25 offen sc1 lds
    buffer_load_dwordx4 v8, s[12:15], s25 offen offset:1024 sc1 lds

    s_waitcnt vmcnt(0)
    s_branch L_ov0
L_ok0:

    s_add_u32 s26, s26, 1
    s_and_b32 s26, s26, 3
    s_barrier

    s_lshl_b32 s23, s26, 13
    s_add_u32 s23, s23, s28
    s_add_u32 s23, s23, 98304
    v_add_u32 v7, s23, v8
    s_mov_b32 s90, 0
    s_waitcnt vmcnt(8)
L_ov1:
    ds_read_b128 v[16:19], v7
    ds_read_b128 v[20:23], v7 offset:1024
    ds_read_b128 v[24:27], v7 offset:32768
    ds_read_b128 v[28:31], v7 offset:33792
    s_waitcnt lgkmcnt(2)
    v_max3_u32 v16, v16, v17, v18
    v_max3_u32 v20, v20, v21, v22
    v_max3_u32 v16, v16, v19, v23
    s_waitcnt lgkmcnt(0)
    v_max3_u32 v24, v24, v25, v26
    v_max3_u32 v28, v28, v29, v30
    v_max3_u32 v24, v24, v27, v31
    v_max3_u32 v16, v16, v20, v24
    v_max_u32 v16, v16, v28
    v_cmp_eq_u32 vcc, -1, v16
    s_add_u32 s90, s90, 1
    s_cbranch_vccz L_ok1
    s_cmp_ge_u32 s90, 100000
    s_cbranch_scc1 L_ok1

    s_lshl_b32 s23, s26, 13
    s_add_u32 s23, s23, s28
    s_add_u32 s24, s23, s27
    s_add_u32 m0, s23, 98304
    s_add_u32 s25, s24, 32768
    buffer_load_dwordx4 v8, s[12:15], s24 offen sc1 lds
    buffer_load_dwordx4 v8, s[12:15], s24 offen offset:1024 sc1 lds
    s_add_u32 m0, s23, 131072
    s_nop 0
    buffer_load_dwordx4 v8, s[12:15], s25 offen sc1 lds
    buffer_load_dwordx4 v8, s[12:15], s25 offen offset:1024 sc1 lds

    s_waitcnt vmcnt(0)
    s_branch L_ov1
L_ok1:

    s_add_u32 s26, s26, 1
    s_and_b32 s26, s26, 3
    s_barrier

    s_lshl_b32 s23, s26, 13
    s_add_u32 s23, s23, s28
    s_add_u32 s23, s23, 98304
    v_add_u32 v7, s23, v8
    s_mov_b32 s90, 0
    s_waitcnt vmcnt(4)
L_ov2:
    ds_read_b128 v[16:19], v7
    ds_read_b128 v[20:23], v7 offset:1024
    ds_read_b128 v[24:27], v7 offset:32768
    ds_read_b128 v[28:31], v7 offset:33792
    s_waitcnt lgkmcnt(2)
    v_max3_u32 v16, v16, v17, v18
    v_max3_u32 v20, v20, v21, v22
    v_max3_u32 v16, v16, v19, v23
    s_waitcnt lgkmcnt(0)
    v_max3_u32 v24, v24, v25, v26
    v_max3_u32 v28, v28, v29, v30
    v_max3_u32 v24, v24, v27, v31
    v_max3_u32 v16, v16, v20, v24
    v_max_u32 v16, v16, v28
    v_cmp_eq_u32 vcc, -1, v16
    s_add_u32 s90, s90, 1
    s_cbranch_vccz L_ok2
    s_cmp_ge_u32 s90, 100000
    s_cbranch_scc1 L_ok2

    s_lshl_b32 s23, s26, 13
    s_add_u32 s23, s23, s28
    s_add_u32 s24, s23, s27
    s_add_u32 m0, s23, 98304
    s_add_u32 s25, s24, 32768
    buffer_load_dwordx4 v8, s[12:15], s24 offen sc1 lds
    buffer_load_dwordx4 v8, s[12:15], s24 offen offset:1024 sc1 lds
    s_add_u32 m0, s23, 131072
    s_nop 0
    buffer_load_dwordx4 v8, s[12:15], s25 offen sc1 lds
    buffer_load_dwordx4 v8, s[12:15], s25 offen offset:1024 sc1 lds

    s_waitcnt vmcnt(0)
    s_branch L_ov2
L_ok2:

    s_add_u32 s26, s26, 1
    s_and_b32 s26, s26, 3
    s_barrier

    s_lshl_b32 s23, s26, 13
    s_add_u32 s23, s23, s28
    s_add_u32 s23, s23, 98304
    v_add_u32 v7, s23, v8
    s_mov_b32 s90, 0
    s_waitcnt vmcnt(0)
L_ov3:
    ds_read_b128 v[16:19], v7
    ds_read_b128 v[20:23], v7 offset:1024
    ds_read_b128 v[24:27], v7 offset:32768
    ds_read_b128 v[28:31], v7 offset:33792
    s_waitcnt lgkmcnt(2)
    v_max3_u32 v16, v16, v17, v18
    v_max3_u32 v20, v20, v21, v22
    v_max3_u32 v16, v16, v19, v23
    s_waitcnt lgkmcnt(0)
    v_max3_u32 v24, v24, v25, v26
    v_max3_u32 v28, v28, v29, v30
    v_max3_u32 v24, v24, v27, v31
    v_max3_u32 v16, v16, v20, v24
    v_max_u32 v16, v16, v28
    v_cmp_eq_u32 vcc, -1, v16
    s_add_u32 s90, s90, 1
    s_cbranch_vccz L_ok3
    s_cmp_ge_u32 s90, 100000
    s_cbranch_scc1 L_ok3

    s_lshl_b32 s23, s26, 13
    s_add_u32 s23, s23, s28
    s_add_u32 s24, s23, s27
    s_add_u32 m0, s23, 98304
    s_add_u32 s25, s24, 32768
    buffer_load_dwordx4 v8, s[12:15], s24 offen sc1 lds
    buffer_load_dwordx4 v8, s[12:15], s24 offen offset:1024 sc1 lds
    s_add_u32 m0, s23, 131072
    s_nop 0
    buffer_load_dwordx4 v8, s[12:15], s25 offen sc1 lds
    buffer_load_dwordx4 v8, s[12:15], s25 offen offset:1024 sc1 lds

    s_waitcnt vmcnt(0)
    s_branch L_ov3
L_ok3:

    s_add_u32 s26, s26, 1
    s_and_b32 s26, s26, 3
    s_barrier

    s_barrier
    s_cmp_eq_u32 s31, 1
    s_cbranch_scc1 L_p3_statw
    s_cmp_ge_u32 s2, 224
    s_cbranch_scc1 L_p3_dn_wait
    s_cmp_lg_u32 s31, 0
    s_cbranch_scc1 L_end

    s_mov_b32 s23, 10534912

    s_mov_b32 s90, 0
    buffer_load_dwordx2 v[12:13], v6, s[12:15], s23 offen offset:0 sc1
    buffer_load_dwordx2 v[14:15], v6, s[12:15], s23 offen offset:512 sc1
    buffer_load_dwordx2 v[16:17], v6, s[12:15], s23 offen offset:1024 sc1
    buffer_load_dwordx2 v[18:19], v6, s[12:15], s23 offen offset:1536 sc1
    s_barrier
    s_branch L_pfcwg
L_pfwg:
    buffer_load_dwordx2 v[12:13], v6, s[12:15], s23 offen offset:0 sc1
    buffer_load_dwordx2 v[14:15], v6, s[12:15], s23 offen offset:512 sc1
    buffer_load_dwordx2 v[16:17], v6, s[12:15], s23 offen offset:1024 sc1
    buffer_load_dwordx2 v[18:19], v6, s[12:15], s23 offen offset:1536 sc1
L_pfcwg:
    s_add_u32 s90, s90, 1
    s_waitcnt vmcnt(0)
    v_cmp_ne_u64 vcc, s[86:87], v[12:13]

    v_cmp_ne_u64 s[92:93], s[86:87], v[14:15]
    s_or_b64 vcc, vcc, s[92:93]
    v_cmp_ne_u64 s[92:93], s[86:87], v[16:17]
    s_or_b64 vcc, vcc, s[92:93]
    v_cmp_ne_u64 s[92:93], s[86:87], v[18:19]
    s_or_b64 vcc, vcc, s[92:93]
    s_cmp_ge_u32 s90, 200000
    s_cbranch_scc1 L_pfdwg
    s_cbranch_vccz L_pfdwg

    s_branch L_pfwg

L_pfdwg:
    s_lshl_b32 s23, s2, 14
    s_add_u32 s23, s23, 16777216

    s_mov_b32 m0, 40960
    s_add_u32 s24, s23, 0
    buffer_load_dwordx4 v8, s[12:15], s24 offen lds
    buffer_load_dwordx4 v8, s[12:15], s24 offen offset:1024 lds
    buffer_load_dwordx4 v8, s[12:15], s24 offen offset:2048 lds
    buffer_load_dwordx4 v8, s[12:15], s24 offen offset:3072 lds
    s_mov_b32 m0, 49216
    s_add_u32 s24, s23, 8192
    buffer_load_dwordx4 v8, s[12:15], s24 offen lds
    buffer_load_dwordx4 v8, s[12:15], s24 offen offset:1024 lds
    buffer_load_dwordx4 v8, s[12:15], s24 offen offset:2048 lds
    buffer_load_dwordx4 v8, s[12:15], s24 offen offset:3072 lds

    s_mov_b32 m0, 45056
    s_add_u32 s24, s23, 4096
    buffer_load_dwordx4 v8, s[12:15], s24 offen lds
    buffer_load_dwordx4 v8, s[12:15], s24 offen offset:1024 lds
    buffer_load_dwordx4 v8, s[12:15], s24 offen offset:2048 lds
    buffer_load_dwordx4 v8, s[12:15], s24 offen offset:3072 lds
    s_mov_b32 m0, 53312
    s_add_u32 s24, s23, 12288
    buffer_load_dwordx4 v8, s[12:15], s24 offen lds
    buffer_load_dwordx4 v8, s[12:15], s24 offen offset:1024 lds
    buffer_load_dwordx4 v8, s[12:15], s24 offen offset:2048 lds
    buffer_load_dwordx4 v8, s[12:15], s24 offen offset:3072 lds

    s_barrier
    v_lshrrev_b32 v2, 4, v1
    v_bfe_u32 v3, v1, 2, 2
    v_lshl_add_u32 v3, v2, 3, v3
    v_lshlrev_b32 v3, 4, v3
    v_and_b32 v4, 1, v1
    v_lshl_add_u32 v3, v4, 3, v3
    v_bfe_u32 v4, v1, 1, 1
    v_mul_u32_u24 v4, 8256, v4
    v_add3_u32 v3, v3, v4, s22
    v_add_u32 v3, 40960, v3
    v_lshlrev_b32 v5, 4, v2
    v_add_u32 v5, 60416, v5
    v_add_u32 v6, 60416, v8
    s_waitcnt vmcnt(0)

    ds_read_b64_tr_b16 v[16:17], v3 offset:0
    ds_read_b64_tr_b16 v[18:19], v3 offset:64
    ds_read_b64_tr_b16 v[20:21], v3 offset:512
    ds_read_b64_tr_b16 v[22:23], v3 offset:576
    ds_read_b64_tr_b16 v[24:25], v3 offset:1024
    ds_read_b64_tr_b16 v[26:27], v3 offset:1088
    ds_read_b64_tr_b16 v[28:29], v3 offset:1536
    ds_read_b64_tr_b16 v[30:31], v3 offset:1600
    s_waitcnt lgkmcnt(0)
    ds_read_b64_tr_b16 v[32:33], v3 offset:2048
    ds_read_b64_tr_b16 v[34:35], v3 offset:2112
    ds_read_b64_tr_b16 v[36:37], v3 offset:2560
    ds_read_b64_tr_b16 v[38:39], v3 offset:2624
    ds_read_b64_tr_b16 v[40:41], v3 offset:3072
    ds_read_b64_tr_b16 v[42:43], v3 offset:3136
    ds_read_b64_tr_b16 v[44:45], v3 offset:3584
    ds_read_b64_tr_b16 v[46:47], v3 offset:3648
    s_waitcnt lgkmcnt(0)
    ds_read_b64_tr_b16 v[48:49], v3 offset:4096
    ds_read_b64_tr_b16 v[50:51], v3 offset:4160
    ds_read_b64_tr_b16 v[52:53], v3 offset:4608
    ds_read_b64_tr_b16 v[54:55], v3 offset:4672
    ds_read_b64_tr_b16 v[56:57], v3 offset:5120
    ds_read_b64_tr_b16 v[58:59], v3 offset:5184
    ds_read_b64_tr_b16 v[60:61], v3 offset:5632
    ds_read_b64_tr_b16 v[62:63], v3 offset:5696
    s_waitcnt lgkmcnt(0)
    ds_read_b64_tr_b16 v[64:65], v3 offset:6144
    ds_read_b64_tr_b16 v[66:67], v3 offset:6208
    ds_read_b64_tr_b16 v[68:69], v3 offset:6656
    ds_read_b64_tr_b16 v[70:71], v3 offset:6720
    ds_read_b64_tr_b16 v[72:73], v3 offset:7168
    ds_read_b64_tr_b16 v[74:75], v3 offset:7232
    ds_read_b64_tr_b16 v[76:77], v3 offset:7680
    ds_read_b64_tr_b16 v[78:79], v3 offset:7744
    s_waitcnt lgkmcnt(0)

    v_lshlrev_b32 v7, 3, v1
    v_and_b32 v7, 255, v7
    s_and_b32 s40, s2, 31
    s_mul_i32 s40, s40, 1280
    s_add_u32 s40, s40, 8724480
    s_mov_b32 s41, 0
    s_mov_b32 s42, -1
L_gs:
    s_mov_b64 exec, -1
    buffer_load_dwordx2 v[96:97], v7, s[12:15], s40 offen sc1
    s_add_u32 s41, s41, 1
    s_waitcnt vmcnt(0)
    v_max_u32 v98, v96, v97
    v_cmp_ne_u32 vcc, -1, v98
    s_cmp_ge_u32 s41, 100000
    s_cselect_b32 s44, 32, 0
    s_bcnt1_i32_b32 s43, vcc_lo
    v_cndmask_b32 v96, v98, v96, vcc
    s_max_u32 s43, s43, s44
    s_cmp_eq_u32 s43, 32
    s_cbranch_scc1 L_gs_go
    s_cmp_lt_u32 s43, 16
    s_cbranch_scc1 L_gs
L_gs_go:

    v_mov_b32 v98, v96
    s_nop 1
    v_max_f32_dpp v98, v98, v98 quad_perm:[1,0,3,2] row_mask:0xf bank_mask:0xf
    s_nop 1
    v_max_f32_dpp v98, v98, v98 quad_perm:[2,3,0,1] row_mask:0xf bank_mask:0xf
    s_nop 1
    v_max_f32_dpp v98, v98, v98 row_half_mirror row_mask:0xf bank_mask:0xf
    s_nop 1
    v_max_f32_dpp v98, v98, v98 row_mirror row_mask:0xf bank_mask:0xf
    s_nop 1
    v_readlane_b32 s25, v98, 0
    v_readlane_b32 s26, v98, 16
    v_readlane_b32 s27, v98, 32
    v_readlane_b32 s28, v98, 48
    s_nop 1
    v_mov_b32 v98, s25
    v_max_f32 v98, s26, v98
    v_max_f32 v98, s27, v98
    v_max_f32 v98, s28, v98
    v_cmp_eq_f32 vcc, v96, v98
    s_nop 1
    s_ff1_i32_b64 s25, vcc
    s_max_i32 s25, s25, 0

    s_and_b32 s52, s25, 31
    s_cmp_eq_u32 s52, s42
    s_cbranch_scc1 L_gs_next
    s_mov_b32 s42, s52

    s_lshl_b32 s23, s52, 11
    s_add_u32 s23, s23, 8650752
    s_mov_b32 s24, 0

L_p3_px:
    buffer_load_dwordx4 v[80:83], v8, s[12:15], s23 offen sc1
    s_add_u32 s24, s24, 1
    s_waitcnt vmcnt(0)
    v_max3_u32 v98, v80, v81, v82
    v_max_u32 v98, v98, v83
    v_cmp_eq_u32 vcc, -1, v98
    s_cmp_ge_u32 s24, 100000
    s_cbranch_scc1 L_p3_pxd
    s_cbranch_vccnz L_p3_px

L_p3_pxd:
    ds_write_b128 v6, v[80:83]

    s_waitcnt lgkmcnt(0)

    ds_read_b128 v[80:83], v5 offset:0
    ds_read_b128 v[84:87], v5 offset:64
    ds_read_b128 v[88:91], v5 offset:128
    ds_read_b128 v[92:95], v5 offset:192
    s_waitcnt lgkmcnt(3)
    v_mfma_f32_16x16x32_bf16 v[96:99], v[80:83], v[16:19], 0
    ds_read_b128 v[80:83], v5 offset:256
    s_waitcnt lgkmcnt(3)
    v_mfma_f32_16x16x32_bf16 v[96:99], v[84:87], v[20:23], v[96:99]
    ds_read_b128 v[84:87], v5 offset:320
    s_waitcnt lgkmcnt(3)
    v_mfma_f32_16x16x32_bf16 v[96:99], v[88:91], v[24:27], v[96:99]
    ds_read_b128 v[88:91], v5 offset:384
    s_waitcnt lgkmcnt(3)
    v_mfma_f32_16x16x32_bf16 v[96:99], v[92:95], v[28:31], v[96:99]
    ds_read_b128 v[92:95], v5 offset:448
    s_waitcnt lgkmcnt(3)
    v_mfma_f32_16x16x32_bf16 v[96:99], v[80:83], v[32:35], v[96:99]
    ds_read_b128 v[80:83], v5 offset:512
    s_waitcnt lgkmcnt(3)
    v_mfma_f32_16x16x32_bf16 v[96:99], v[84:87], v[36:39], v[96:99]
    ds_read_b128 v[84:87], v5 offset:576
    s_waitcnt lgkmcnt(3)
    v_mfma_f32_16x16x32_bf16 v[96:99], v[88:91], v[40:43], v[96:99]
    ds_read_b128 v[88:91], v5 offset:640
    s_waitcnt lgkmcnt(3)
    v_mfma_f32_16x16x32_bf16 v[96:99], v[92:95], v[44:47], v[96:99]
    ds_read_b128 v[92:95], v5 offset:704
    s_waitcnt lgkmcnt(3)
    v_mfma_f32_16x16x32_bf16 v[96:99], v[80:83], v[48:51], v[96:99]
    ds_read_b128 v[80:83], v5 offset:768
    s_waitcnt lgkmcnt(3)
    v_mfma_f32_16x16x32_bf16 v[96:99], v[84:87], v[52:55], v[96:99]
    ds_read_b128 v[84:87], v5 offset:832
    s_waitcnt lgkmcnt(3)
    v_mfma_f32_16x16x32_bf16 v[96:99], v[88:91], v[56:59], v[96:99]
    ds_read_b128 v[88:91], v5 offset:896
    s_waitcnt lgkmcnt(3)
    v_mfma_f32_16x16x32_bf16 v[96:99], v[92:95], v[60:63], v[96:99]
    ds_read_b128 v[92:95], v5 offset:960
    s_waitcnt lgkmcnt(3)
    v_mfma_f32_16x16x32_bf16 v[96:99], v[80:83], v[64:67], v[96:99]
    s_waitcnt lgkmcnt(2)
    v_mfma_f32_16x16x32_bf16 v[96:99], v[84:87], v[68:71], v[96:99]
    s_waitcnt lgkmcnt(1)
    v_mfma_f32_16x16x32_bf16 v[96:99], v[88:91], v[72:75], v[96:99]
    s_waitcnt lgkmcnt(0)
    v_mfma_f32_16x16x32_bf16 v[96:99], v[92:95], v[76:79], v[96:99]
    s_nop 7
    v_cvt_pk_bf16_f32 v100, v96, v96
    v_lshlrev_b32 v100, 16, v100
    v_mul_f32 v101, 0xbfb8aa3b, v100
    v_exp_f32 v101, v101
    v_mov_b32_dpp v102, v100 row_ror:8 row_mask:0xf bank_mask:0xf
    v_add_f32 v101, 1.0, v101
    v_rcp_f32 v101, v101
    s_nop 0
    v_mul_f32 v101, v100, v101
    v_cvt_pk_bf16_f32 v101, v101, v101
    v_lshlrev_b32 v101, 16, v101
    v_mul_f32 v101, v101, v102
    s_nop 1
    v_mov_b32_dpp v102, v101 quad_perm:[1,0,3,2] row_mask:0xf bank_mask:0xf
    v_lshlrev_b32 v2, 1, v1
    v_cvt_pk_bf16_f32 v103, v101, v102
    s_lshl_b32 s23, s2, 4
    s_lshl_b32 s24, s52, 12
    s_add_u32 s23, s23, s24
    s_add_u32 s23, s23, 8781824
    v_min_u32 v103, 0xfffffffe, v103
    s_mov_b64 exec, 0x55
    buffer_store_dword v103, v2, s[12:15], s23 offen sc1

L_gs_next:
    s_cmp_lt_u32 s43, 32
    s_cbranch_scc1 L_gs

    s_endpgm
L_p3_statw:
    v_add_u32 v2, 57600, v8
    s_lshl_b32 s23, s19, 13
    s_add_u32 s23, s23, 8388608
    s_lshl_b32 s24, s20, 10
    s_add_u32 s24, s24, s23
    s_barrier
    ds_read_b128 v[16:19], v2
    ds_read_b128 v[20:23], v2 offset:1024
    s_waitcnt lgkmcnt(0)
    v_add_f32 v16, v16, v20
    v_add_f32 v17, v17, v21
    v_add_f32 v18, v18, v22
    v_min_u32 v16, 0xfffffffe, v16
    v_min_u32 v17, 0xfffffffe, v17
    v_min_u32 v18, 0xfffffffe, v18
    v_mov_b32 v19, 0
    s_add_u32 s26, s24, 524288
    buffer_store_dwordx4 v[16:19], v8, s[12:15], s26 offen
    buffer_store_dwordx4 v[16:19], v8, s[12:15], s24 offen sc1

    s_mov_b32 s24, 0
    s_add_u32 s25, s23, 4096
    s_add_u32 s26, s23, 524288
    s_add_u32 s27, s25, 524288

L_p3_pr:
    buffer_load_dwordx4 v[16:19], v8, s[12:15], s26 offen offset:0 nt
    buffer_load_dwordx4 v[20:23], v8, s[12:15], s26 offen offset:1024 nt
    buffer_load_dwordx4 v[24:27], v8, s[12:15], s26 offen offset:2048 nt
    buffer_load_dwordx4 v[28:31], v8, s[12:15], s26 offen offset:3072 nt
    buffer_load_dwordx4 v[32:35], v8, s[12:15], s27 offen offset:0 nt
    buffer_load_dwordx4 v[36:39], v8, s[12:15], s27 offen offset:1024 nt
    buffer_load_dwordx4 v[40:43], v8, s[12:15], s27 offen offset:2048 nt
    buffer_load_dwordx4 v[44:47], v8, s[12:15], s27 offen offset:3072 nt
    s_add_u32 s24, s24, 1
    s_waitcnt vmcnt(0)
    v_max3_u32 v2, v16, v17, v18

    v_max3_u32 v3, v20, v21, v22
    v_max_u32 v2, v2, v3
    v_max3_u32 v3, v24, v25, v26
    v_max_u32 v2, v2, v3
    v_max3_u32 v3, v28, v29, v30
    v_max_u32 v2, v2, v3
    v_max3_u32 v3, v32, v33, v34
    v_max_u32 v2, v2, v3
    v_max3_u32 v3, v36, v37, v38
    v_max_u32 v2, v2, v3
    v_max3_u32 v3, v40, v41, v42
    v_max_u32 v2, v2, v3
    v_max3_u32 v3, v44, v45, v46
    v_max_u32 v2, v2, v3
    v_cmp_eq_u32 vcc, -1, v2
    s_and_b32 s28, s24, 3
    s_cbranch_vccz L_p3_prd
    s_cmp_lg_u32 s28, 3
    s_cbranch_scc1 L_p3_pr

    buffer_load_dwordx4 v[16:19], v8, s[12:15], s23 offen offset:0 sc1
    buffer_load_dwordx4 v[20:23], v8, s[12:15], s23 offen offset:1024 sc1
    buffer_load_dwordx4 v[24:27], v8, s[12:15], s23 offen offset:2048 sc1
    buffer_load_dwordx4 v[28:31], v8, s[12:15], s23 offen offset:3072 sc1
    buffer_load_dwordx4 v[32:35], v8, s[12:15], s25 offen offset:0 sc1
    buffer_load_dwordx4 v[36:39], v8, s[12:15], s25 offen offset:1024 sc1
    buffer_load_dwordx4 v[40:43], v8, s[12:15], s25 offen offset:2048 sc1
    buffer_load_dwordx4 v[44:47], v8, s[12:15], s25 offen offset:3072 sc1
    s_add_u32 s24, s24, 1
    s_waitcnt vmcnt(0)
    v_max3_u32 v2, v16, v17, v18

    v_max3_u32 v3, v20, v21, v22
    v_max_u32 v2, v2, v3
    v_max3_u32 v3, v24, v25, v26
    v_max_u32 v2, v2, v3
    v_max3_u32 v3, v28, v29, v30
    v_max_u32 v2, v2, v3
    v_max3_u32 v3, v32, v33, v34
    v_max_u32 v2, v2, v3
    v_max3_u32 v3, v36, v37, v38
    v_max_u32 v2, v2, v3
    v_max3_u32 v3, v40, v41, v42
    v_max_u32 v2, v2, v3
    v_max3_u32 v3, v44, v45, v46
    v_max_u32 v2, v2, v3
    v_cmp_eq_u32 vcc, -1, v2
    s_cmp_ge_u32 s24, 100000
    s_cbranch_scc1 L_p3_prd
    s_cbranch_vccnz L_p3_pr

L_p3_prd:

    v_add_f32 v16, v16, v20
    v_add_f32 v17, v17, v21
    v_add_f32 v18, v18, v22
    v_add_f32 v16, v16, v24
    v_add_f32 v17, v17, v25
    v_add_f32 v18, v18, v26
    v_add_f32 v16, v16, v28
    v_add_f32 v17, v17, v29
    v_add_f32 v18, v18, v30
    v_add_f32 v16, v16, v32
    v_add_f32 v17, v17, v33
    v_add_f32 v18, v18, v34
    v_add_f32 v16, v16, v36
    v_add_f32 v17, v17, v37
    v_add_f32 v18, v18, v38
    v_add_f32 v16, v16, v40
    v_add_f32 v17, v17, v41
    v_add_f32 v18, v18, v42
    v_add_f32 v16, v16, v44
    v_add_f32 v17, v17, v45
    v_add_f32 v18, v18, v46
    v_mul_f32 v16, 0x3b000000, v16
    v_mul_f32 v17, 0x3b000000, v17
    v_fma_f32 v17, -v16, v16, v17
    v_max_f32 v17, 0, v17
    v_add_f32 v17, 0x3727c5ac, v17
    v_rsq_f32 v20, v17
    v_fma_f32 v18, -v16, v10, v18
    v_lshrrev_b32 v2, 1, v8
    v_mul_f32 v21, -v16, v20
    v_mul_f32 v22, v18, v20
    ds_write_b64 v2, v[20:21] offset:59648

    v_mov_b32 v23, v22
    s_nop 1
    v_max_f32_dpp v23, v23, v23 quad_perm:[1,0,3,2] row_mask:0xf bank_mask:0xf
    s_nop 1
    v_max_f32_dpp v23, v23, v23 quad_perm:[2,3,0,1] row_mask:0xf bank_mask:0xf
    s_nop 1
    v_max_f32_dpp v23, v23, v23 row_half_mirror row_mask:0xf bank_mask:0xf
    s_nop 1
    v_max_f32_dpp v23, v23, v23 row_mirror row_mask:0xf bank_mask:0xf
    s_nop 1
    v_readlane_b32 s25, v23, 0
    v_readlane_b32 s26, v23, 16
    v_readlane_b32 s27, v23, 32
    v_readlane_b32 s28, v23, 48
    s_nop 1
    v_mov_b32 v23, s25
    v_max_f32 v23, s26, v23
    v_max_f32 v23, s27, v23
    v_max_f32 v23, s28, v23
    v_cmp_eq_f32 vcc, v22, v23
    s_nop 1
    s_ff1_i32_b64 s25, vcc
    s_max_i32 s25, s25, 0

    v_mov_b32 v3, s25
    v_mov_b32 v4, 60160
    ds_write_b32 v4, v3
    s_cmp_lg_u32 s20, 0
    s_cbranch_scc1 L_p3_nobest
    v_readlane_b32 s26, v22, s25
    s_lshl_b32 s27, s19, 6
    s_add_u32 s27, s27, s25
    s_min_u32 s26, s26, 0xfffffffe
    v_mov_b32 v24, s26
    v_mov_b32 v25, s27
    s_lshl_b32 s23, s19, 3
    s_add_u32 s23, s23, 8724480
    v_mul_u32_u24 v3, 1280, v1
    s_mov_b32 exec_hi, 0
    buffer_store_dwordx2 v[24:25], v3, s[12:15], s23 offen sc1
    s_mov_b64 exec, -1

L_p3_nobest:
    s_waitcnt lgkmcnt(0)
    s_barrier

    s_cmp_ge_u32 s2, 224
    s_cbranch_scc1 L_p3_dn

    s_endpgm
L_p3_dn_wait:
    s_barrier
    s_barrier
L_p3_dn:
    v_lshlrev_b32 v6, 3, v1
    s_mov_b32 s23, 10534912

    s_mov_b32 s90, 0
L_pfwd:
    buffer_load_dwordx2 v[12:13], v6, s[12:15], s23 offen offset:0 sc1
    buffer_load_dwordx2 v[14:15], v6, s[12:15], s23 offen offset:512 sc1
    buffer_load_dwordx2 v[16:17], v6, s[12:15], s23 offen offset:1024 sc1
    buffer_load_dwordx2 v[18:19], v6, s[12:15], s23 offen offset:1536 sc1
L_pfcwd:
    s_add_u32 s90, s90, 1
    s_waitcnt vmcnt(0)
    v_cmp_ne_u64 vcc, s[86:87], v[12:13]

    v_cmp_ne_u64 s[92:93], s[86:87], v[14:15]
    s_or_b64 vcc, vcc, s[92:93]
    v_cmp_ne_u64 s[92:93], s[86:87], v[16:17]
    s_or_b64 vcc, vcc, s[92:93]
    v_cmp_ne_u64 s[92:93], s[86:87], v[18:19]
    s_or_b64 vcc, vcc, s[92:93]
    s_cmp_ge_u32 s90, 200000
    s_cbranch_scc1 L_pfdwd
    s_cbranch_vccz L_pfdwd

    s_branch L_pfwd

L_pfdwd:
    s_sub_u32 s29, s2, 224
    s_mul_i32 s30, s31, 14336
    s_mul_i32 s23, s29, 57344
    s_add_u32 s23, s23, s30
    s_add_u32 s23, s23, 20971520
    s_add_u32 s30, s30, 65536

    s_add_u32 m0, s30, 0
    s_add_u32 s24, s23, 0

    buffer_load_dwordx4 v8, s[12:15], s24 offen offset:0 lds
    buffer_load_dwordx4 v8, s[12:15], s24 offen offset:1024 lds
    buffer_load_dwordx4 v8, s[12:15], s24 offen offset:2048 lds
    buffer_load_dwordx4 v8, s[12:15], s24 offen offset:3072 lds
    s_add_u32 m0, s30, 4096
    s_add_u32 s24, s23, 4096

    buffer_load_dwordx4 v8, s[12:15], s24 offen offset:0 lds
    buffer_load_dwordx4 v8, s[12:15], s24 offen offset:1024 lds
    buffer_load_dwordx4 v8, s[12:15], s24 offen offset:2048 lds
    buffer_load_dwordx4 v8, s[12:15], s24 offen offset:3072 lds
    s_add_u32 m0, s30, 8192
    s_add_u32 s24, s23, 8192

    buffer_load_dwordx4 v8, s[12:15], s24 offen offset:0 lds
    buffer_load_dwordx4 v8, s[12:15], s24 offen offset:1024 lds
    buffer_load_dwordx4 v8, s[12:15], s24 offen offset:2048 lds
    buffer_load_dwordx4 v8, s[12:15], s24 offen offset:3072 lds
    s_add_u32 m0, s30, 12288
    s_add_u32 s24, s23, 12288

    buffer_load_dwordx4 v8, s[12:15], s24 offen offset:0 lds
    buffer_load_dwordx4 v8, s[12:15], s24 offen offset:1024 lds
    v_lshl_add_u32 v3, v1, 3, s30
    s_mul_i32 s26, s31, 896
    s_add_u32 s27, s26, 0
    v_add_u32 v6, s27, v8
    v_lshrrev_b32 v5, 4, v1
    v_lshl_add_u32 v5, v5, 3, s27
    s_add_u32 s55, s26, 8781824
    s_waitcnt vmcnt(0)

    ds_read_b64_tr_b16 v[16:17], v3 offset:0
    ds_read_b64_tr_b16 v[18:19], v3 offset:512
    ds_read_b64_tr_b16 v[20:21], v3 offset:1024
    ds_read_b64_tr_b16 v[22:23], v3 offset:1536
    ds_read_b64_tr_b16 v[24:25], v3 offset:2048
    ds_read_b64_tr_b16 v[26:27], v3 offset:2560
    ds_read_b64_tr_b16 v[28:29], v3 offset:3072
    ds_read_b64_tr_b16 v[30:31], v3 offset:3584
    s_waitcnt lgkmcnt(0)
    ds_read_b64_tr_b16 v[32:33], v3 offset:4096
    ds_read_b64_tr_b16 v[34:35], v3 offset:4608
    ds_read_b64_tr_b16 v[36:37], v3 offset:5120
    ds_read_b64_tr_b16 v[38:39], v3 offset:5632
    ds_read_b64_tr_b16 v[40:41], v3 offset:6144
    ds_read_b64_tr_b16 v[42:43], v3 offset:6656
    ds_read_b64_tr_b16 v[44:45], v3 offset:7168
    ds_read_b64_tr_b16 v[46:47], v3 offset:7680
    s_waitcnt lgkmcnt(0)
    ds_read_b64_tr_b16 v[48:49], v3 offset:8192
    ds_read_b64_tr_b16 v[50:51], v3 offset:8704
    ds_read_b64_tr_b16 v[52:53], v3 offset:9216
    ds_read_b64_tr_b16 v[54:55], v3 offset:9728
    ds_read_b64_tr_b16 v[56:57], v3 offset:10240
    ds_read_b64_tr_b16 v[58:59], v3 offset:10752
    ds_read_b64_tr_b16 v[60:61], v3 offset:11264
    ds_read_b64_tr_b16 v[62:63], v3 offset:11776
    s_waitcnt lgkmcnt(0)
    ds_read_b64_tr_b16 v[64:65], v3 offset:12288
    ds_read_b64_tr_b16 v[66:67], v3 offset:12800
    ds_read_b64_tr_b16 v[68:69], v3 offset:13312
    ds_read_b64_tr_b16 v[70:71], v3 offset:13824
    s_waitcnt lgkmcnt(0)

    v_lshlrev_b32 v7, 3, v1
    v_and_b32 v7, 255, v7
    s_and_b32 s23, s2, 31
    s_mul_i32 s23, s23, 1280
    s_add_u32 s23, s23, 8724480
    s_mov_b32 s24, 0

L_p3_pbd:
    s_sleep 1
    buffer_load_dwordx2 v[96:97], v7, s[12:15], s23 offen sc1
    s_add_u32 s24, s24, 1
    s_waitcnt vmcnt(0)
    v_max_u32 v98, v96, v97
    v_cmp_eq_u32 vcc, -1, v98
    s_cmp_ge_u32 s24, 100000
    s_cbranch_scc1 L_p3_pbdd
    s_cbranch_vccnz L_p3_pbd

L_p3_pbdd:
    v_mov_b32 v98, v96
    s_nop 1
    v_max_f32_dpp v98, v98, v98 quad_perm:[1,0,3,2] row_mask:0xf bank_mask:0xf
    s_nop 1
    v_max_f32_dpp v98, v98, v98 quad_perm:[2,3,0,1] row_mask:0xf bank_mask:0xf
    s_nop 1
    v_max_f32_dpp v98, v98, v98 row_half_mirror row_mask:0xf bank_mask:0xf
    s_nop 1
    v_max_f32_dpp v98, v98, v98 row_mirror row_mask:0xf bank_mask:0xf
    s_nop 1
    v_readlane_b32 s25, v98, 0
    v_readlane_b32 s26, v98, 16
    v_readlane_b32 s27, v98, 32
    v_readlane_b32 s28, v98, 48
    s_nop 1
    v_mov_b32 v98, s25
    v_max_f32 v98, s26, v98
    v_max_f32 v98, s27, v98
    v_max_f32 v98, s28, v98
    v_cmp_eq_f32 vcc, v96, v98
    s_nop 1
    s_ff1_i32_b64 s25, vcc
    s_max_i32 s25, s25, 0

    s_and_b32 s52, s25, 31
    s_nop 3
    v_readlane_b32 s53, v97, s52
    v_readlane_b32 s54, v96, s52
    s_and_b32 s53, s53, 2047

    s_lshl_b32 s23, s52, 12
    s_add_u32 s55, s55, s23

    s_lshl_b32 s40, s52, 11
    s_add_u32 s40, s40, 8650752
    s_lshl_b32 s24, s29, 5
    s_add_u32 s40, s40, s24
    v_and_b32 v7, 7, v1
    v_lshlrev_b32 v7, 2, v7
    buffer_load_dword v108, v7, s[12:15], s40 offen sc1
    buffer_load_dword v109, v7, s[12:15], s40 offen offset:1024 sc1

L_p3_dn_nb:
    s_mov_b32 s24, 0
    s_mov_b32 exec_hi, 0x00ffffff

L_p3_pa:
    buffer_load_dwordx4 v[80:83], v8, s[12:15], s55 offen sc1
    s_add_u32 s24, s24, 1
    s_waitcnt vmcnt(0)
    v_max3_u32 v98, v80, v81, v82
    v_max_u32 v98, v98, v83
    v_cmp_eq_u32 vcc, -1, v98
    s_cmp_ge_u32 s24, 100000
    s_cbranch_scc1 L_p3_pad
    s_cbranch_vccnz L_p3_pa

L_p3_pad:
    ds_write_b128 v6, v[80:83]
    s_mov_b64 exec, -1

    s_waitcnt lgkmcnt(0)

    ds_read2_b64 v[80:83], v5 offset0:0 offset1:4
    ds_read2_b64 v[84:87], v5 offset0:8 offset1:12
    ds_read2_b64 v[88:91], v5 offset0:16 offset1:20
    ds_read2_b64 v[92:95], v5 offset0:24 offset1:28
    s_waitcnt lgkmcnt(3)
    v_mfma_f32_16x16x32_bf16 v[96:99], v[80:83], v[16:19], 0
    ds_read2_b64 v[80:83], v5 offset0:32 offset1:36
    s_waitcnt lgkmcnt(3)
    v_mfma_f32_16x16x32_bf16 v[96:99], v[84:87], v[20:23], v[96:99]
    ds_read2_b64 v[84:87], v5 offset0:40 offset1:44
    s_waitcnt lgkmcnt(3)
    v_mfma_f32_16x16x32_bf16 v[96:99], v[88:91], v[24:27], v[96:99]
    ds_read2_b64 v[88:91], v5 offset0:48 offset1:52
    s_waitcnt lgkmcnt(3)
    v_mfma_f32_16x16x32_bf16 v[96:99], v[92:95], v[28:31], v[96:99]
    ds_read2_b64 v[92:95], v5 offset0:56 offset1:60
    s_waitcnt lgkmcnt(3)
    v_mfma_f32_16x16x32_bf16 v[96:99], v[80:83], v[32:35], v[96:99]
    ds_read2_b64 v[80:83], v5 offset0:64 offset1:68
    s_waitcnt lgkmcnt(3)
    v_mfma_f32_16x16x32_bf16 v[96:99], v[84:87], v[36:39], v[96:99]
    ds_read2_b64 v[84:87], v5 offset0:72 offset1:76
    s_waitcnt lgkmcnt(3)
    v_mfma_f32_16x16x32_bf16 v[96:99], v[88:91], v[40:43], v[96:99]
    ds_read2_b64 v[88:91], v5 offset0:80 offset1:84
    s_waitcnt lgkmcnt(3)
    v_mfma_f32_16x16x32_bf16 v[96:99], v[92:95], v[44:47], v[96:99]
    ds_read2_b64 v[92:95], v5 offset0:88 offset1:92
    s_waitcnt lgkmcnt(3)
    v_mfma_f32_16x16x32_bf16 v[96:99], v[80:83], v[48:51], v[96:99]
    ds_read2_b64 v[80:83], v5 offset0:96 offset1:100
    s_waitcnt lgkmcnt(3)
    v_mfma_f32_16x16x32_bf16 v[96:99], v[84:87], v[52:55], v[96:99]
    ds_read2_b64 v[84:87], v5 offset0:104 offset1:108
    s_waitcnt lgkmcnt(3)
    v_mfma_f32_16x16x32_bf16 v[96:99], v[88:91], v[56:59], v[96:99]
    s_waitcnt lgkmcnt(2)
    v_mfma_f32_16x16x32_bf16 v[96:99], v[92:95], v[60:63], v[96:99]
    s_waitcnt lgkmcnt(1)
    v_mfma_f32_16x16x32_bf16 v[96:99], v[80:83], v[64:67], v[96:99]
    s_waitcnt lgkmcnt(0)
    v_mfma_f32_16x16x32_bf16 v[96:99], v[84:87], v[68:71], v[96:99]
    v_and_b32 v2, 15, v1
    v_lshlrev_b32 v2, 4, v2
    s_lshl_b32 s23, s31, 2
    s_add_u32 s23, s23, 4096
    v_add_u32 v3, s23, v2
    s_nop 3
    ds_write_b32 v3, v96
    s_waitcnt lgkmcnt(0)
    s_barrier
    s_cmp_lg_u32 s31, 0
    s_cbranch_scc1 L_end
    s_mov_b32 s24, 0
L_p3_pc:
    v_max_u32 v98, v108, v109
    s_add_u32 s24, s24, 1
    v_cmp_eq_u32 vcc, -1, v98
    s_cmp_ge_u32 s24, 100000
    s_cbranch_scc1 L_p3_pcd
    s_cbranch_vccz L_p3_pcd
    buffer_load_dword v108, v7, s[12:15], s40 offen sc1
    buffer_load_dword v109, v7, s[12:15], s40 offen offset:1024 sc1
    s_waitcnt vmcnt(0)
    s_branch L_p3_pc
L_p3_pcd:
    v_and_b32 v7, 7, v1
    v_lshlrev_b32 v7, 2, v7
    v_lshlrev_b32 v2, 5, v1
    v_and_b32 v2, 255, v2
    v_add_u32 v2, 4096, v2
    ds_read_b128 v[80:83], v2
    ds_read_b128 v[84:87], v2 offset:16
    v_mov_b32 v100, s54
    v_cvt_pk_bf16_f32 v100, v100, v100
    v_lshlrev_b32 v100, 16, v100
    v_mul_f32 v100, 0xbfb8aa3b, v100
    v_exp_f32 v100, v100
    s_mov_b32 s30, 0xffff0000
    v_add_f32 v100, 1.0, v100
    v_rcp_f32 v100, v100
    s_nop 0
    v_cvt_pk_bf16_f32 v100, v100, v100
    v_lshlrev_b32 v100, 16, v100
    s_waitcnt lgkmcnt(0)
    v_add_f32 v80, v80, v81
    v_add_f32 v82, v82, v83
    v_add_f32 v84, v84, v85
    v_add_f32 v86, v86, v87
    v_add_f32 v80, v80, v82
    v_add_f32 v81, v84, v86
    v_cvt_pk_bf16_f32 v82, v80, v81
    v_lshlrev_b32 v80, 16, v82
    v_and_b32 v81, s30, v82
    v_mul_f32 v80, v80, v100
    v_mul_f32 v81, v81, v100
    v_cvt_pk_bf16_f32 v82, v80, v81
    v_lshlrev_b32 v80, 16, v82
    v_and_b32 v81, s30, v82
    v_lshlrev_b32 v82, 16, v108
    v_and_b32 v83, s30, v108
    v_add_f32 v80, v80, v82
    v_add_f32 v81, v81, v83
    v_cvt_pk_bf16_f32 v82, v80, v81
    v_lshlrev_b32 v80, 16, v82
    v_and_b32 v81, s30, v82
    v_lshlrev_b32 v82, 16, v109
    v_and_b32 v83, s30, v109
    v_add_f32 v80, v80, v82
    v_add_f32 v81, v81, v83
    v_cvt_pk_bf16_f32 v82, v80, v81
    s_lshl_b32 s23, s53, 10
    s_lshl_b32 s24, s29, 5
    s_add_u32 s23, s23, s24
    s_mov_b64 exec, 0xff
    buffer_store_dword v82, v7, s[32:35], s23 offen

    s_endpgm
L_p3_mfma:
    v_lshrrev_b32 v2, 5, v1
    v_lshlrev_b32 v6, 3, v2
    s_lshl_b32 s23, s20, 7
    s_lshl_b32 s24, s18, 6
    s_add_u32 s23, s23, s24
    buffer_load_dwordx2 v[112:113], v6, s[36:39], s23 offen
    buffer_load_dwordx2 v[114:115], v6, s[36:39], s23 offen offset:16
    buffer_load_dwordx2 v[116:117], v6, s[36:39], s23 offen offset:32
    buffer_load_dwordx2 v[118:119], v6, s[36:39], s23 offen offset:48
    s_lshr_b32 s29, s16, 3
    v_bfe_u32 v3, v1, 2, 2
    v_lshl_add_u32 v4, v2, 2, v3
    v_lshlrev_b32 v4, 7, v4
    v_lshrrev_b32 v3, 1, v3
    v_xor_b32 v3, s18, v3
    v_lshl_add_u32 v4, v3, 6, v4
    v_bfe_u32 v3, v1, 4, 1
    v_lshl_add_u32 v4, v3, 5, v4
    v_and_b32 v3, 3, v1
    v_lshl_add_u32 v4, v3, 3, v4
    s_lshl_b32 s23, s29, 13
    v_add_u32 v4, s23, v4
    s_lshl_b32 s23, s17, 15
    s_add_u32 s23, s23, 98304
    s_lshl_b32 s24, s29, 12
    s_add_u32 s23, s23, s24
    v_lshl_add_u32 v5, v1, 4, s23
    s_mov_b32 s30, 0xffff0000
    v_and_b32 v3, 31, v1
    s_lshl_b32 s23, s17, 12
    s_add_u32 s23, s23, 32768
    v_lshl_add_u32 v28, v3, 7, s23
    v_add_u32 v28, v28, v6
    v_and_b32 v29, 7, v1
    s_lshl_b32 s23, s18, 2
    v_xor_b32 v29, s23, v29
    v_lshlrev_b32 v29, 4, v29

    v_xor_b32 v24, 0, v29
    v_add_u32 v24, v24, v28
    ds_read_b64 v[16:17], v24
    v_xor_b32 v25, 16, v29
    v_add_u32 v25, v25, v28
    ds_read_b64 v[18:19], v25
    v_xor_b32 v26, 32, v29
    v_add_u32 v26, v26, v28
    ds_read_b64 v[20:21], v26
    v_xor_b32 v27, 48, v29
    v_add_u32 v27, v27, v28
    ds_read_b64 v[22:23], v27
    s_mov_b32 s25, s21
    s_and_b32 s23, s25, 1
    s_lshl_b32 s23, s23, 14
    s_lshr_b32 s24, s25, 1
    s_lshl_b32 s24, s24, 16
    s_add_u32 s23, s23, s24
    v_add_u32 v9, s23, v4
    s_add_u32 s25, s25, 1
    s_and_b32 s25, s25, 3

    s_waitcnt lgkmcnt(0)
    s_cmp_eq_u32 s29, 0
    s_cselect_b32 s26, s30, 0
    s_cselect_b32 s27, 16, 32
    ds_read_b64_tr_b16 v[32:33], v9 offset:0
    ds_read_b64_tr_b16 v[34:35], v9 offset:1024
    ds_read_b64_tr_b16 v[36:37], v9 offset:2048
    ds_read_b64_tr_b16 v[38:39], v9 offset:3072
    ds_read_b64_tr_b16 v[40:41], v9 offset:4096
    ds_read_b64_tr_b16 v[42:43], v9 offset:5120
    ds_read_b64_tr_b16 v[44:45], v9 offset:6144
    ds_read_b64_tr_b16 v[46:47], v9 offset:7168
    v_lshlrev_b32 v96, 16, v16
    v_and_b32 v97, s26, v16
    v_and_b32 v96, s26, v96
    v_lshlrev_b32 v98, 16, v17
    v_and_b32 v99, s26, v17
    v_and_b32 v98, s26, v98
    v_lshlrev_b32 v100, 16, v18
    v_and_b32 v101, s26, v18
    v_and_b32 v100, s26, v100
    v_lshlrev_b32 v102, 16, v19
    v_and_b32 v103, s26, v19
    v_and_b32 v102, s26, v102
    v_lshlrev_b32 v104, 16, v20
    v_and_b32 v105, s26, v20
    v_and_b32 v104, s26, v104
    v_lshlrev_b32 v106, 16, v21
    v_and_b32 v107, s26, v21
    v_and_b32 v106, s26, v106
    v_lshlrev_b32 v108, 16, v22
    v_and_b32 v109, s26, v22
    v_and_b32 v108, s26, v108
    v_lshlrev_b32 v110, 16, v23
    v_and_b32 v111, s26, v23
    v_and_b32 v110, s26, v110
    s_waitcnt lgkmcnt(0)
    s_and_b32 s23, s25, 1
    s_lshl_b32 s23, s23, 14
    s_lshr_b32 s24, s25, 1
    s_lshl_b32 s24, s24, 16
    s_add_u32 s23, s23, s24
    v_add_u32 v9, s23, v4
    s_add_u32 s25, s25, 1
    s_and_b32 s25, s25, 3

    ds_read_b64_tr_b16 v[48:49], v9 offset:0
    ds_read_b64_tr_b16 v[50:51], v9 offset:1024
    ds_read_b64_tr_b16 v[52:53], v9 offset:2048
    ds_read_b64_tr_b16 v[54:55], v9 offset:3072
    ds_read_b64_tr_b16 v[56:57], v9 offset:4096
    ds_read_b64_tr_b16 v[58:59], v9 offset:5120
    ds_read_b64_tr_b16 v[60:61], v9 offset:6144
    ds_read_b64_tr_b16 v[62:63], v9 offset:7168
    s_waitcnt lgkmcnt(0)
    s_and_b32 s23, s25, 1
    s_lshl_b32 s23, s23, 14
    s_lshr_b32 s24, s25, 1
    s_lshl_b32 s24, s24, 16
    s_add_u32 s23, s23, s24
    v_add_u32 v9, s23, v4
    s_add_u32 s25, s25, 1
    s_and_b32 s25, s25, 3

    ds_read_b64_tr_b16 v[64:65], v9 offset:0
    ds_read_b64_tr_b16 v[66:67], v9 offset:1024
    ds_read_b64_tr_b16 v[68:69], v9 offset:2048
    ds_read_b64_tr_b16 v[70:71], v9 offset:3072
    ds_read_b64_tr_b16 v[72:73], v9 offset:4096
    ds_read_b64_tr_b16 v[74:75], v9 offset:5120
    ds_read_b64_tr_b16 v[76:77], v9 offset:6144
    ds_read_b64_tr_b16 v[78:79], v9 offset:7168
    s_waitcnt lgkmcnt(0)
    s_and_b32 s23, s25, 1
    s_lshl_b32 s23, s23, 14
    s_lshr_b32 s24, s25, 1
    s_lshl_b32 s24, s24, 16
    s_add_u32 s23, s23, s24
    v_add_u32 v9, s23, v4
    s_add_u32 s25, s25, 1
    s_and_b32 s25, s25, 3

    ds_read_b64_tr_b16 v[80:81], v9 offset:0
    ds_read_b64_tr_b16 v[82:83], v9 offset:1024
    ds_read_b64_tr_b16 v[84:85], v9 offset:2048
    ds_read_b64_tr_b16 v[86:87], v9 offset:3072
    ds_read_b64_tr_b16 v[88:89], v9 offset:4096
    ds_read_b64_tr_b16 v[90:91], v9 offset:5120
    ds_read_b64_tr_b16 v[92:93], v9 offset:6144
    ds_read_b64_tr_b16 v[94:95], v9 offset:7168
    s_waitcnt lgkmcnt(0)
    s_barrier
    s_lshl_b32 s23, s21, 13
    v_add_u32 v8, s23, v5
    s_add_u32 s21, s21, 1
    s_and_b32 s21, s21, 3
    s_barrier

    ds_read_b128 v[16:19], v8 offset:0
    ds_read_b128 v[20:23], v8 offset:1024
    ds_read_b128 v[24:27], v8 offset:2048
    ds_read_b128 v[28:31], v8 offset:3072
    s_waitcnt lgkmcnt(3)
    v_mfma_f32_32x32x16_bf16 v[96:111], v[32:35], v[16:19], v[96:111]
    s_waitcnt lgkmcnt(2)
    v_mfma_f32_32x32x16_bf16 v[96:111], v[36:39], v[20:23], v[96:111]
    s_waitcnt lgkmcnt(1)
    v_mfma_f32_32x32x16_bf16 v[96:111], v[40:43], v[24:27], v[96:111]
    s_waitcnt lgkmcnt(0)
    v_mfma_f32_32x32x16_bf16 v[96:111], v[44:47], v[28:31], v[96:111]
    s_lshl_b32 s23, s21, 13
    v_add_u32 v8, s23, v5
    s_add_u32 s21, s21, 1
    s_and_b32 s21, s21, 3
    s_barrier

    ds_read_b128 v[16:19], v8 offset:0
    ds_read_b128 v[20:23], v8 offset:1024
    ds_read_b128 v[24:27], v8 offset:2048
    ds_read_b128 v[28:31], v8 offset:3072
    s_waitcnt lgkmcnt(3)
    v_mfma_f32_32x32x16_bf16 v[96:111], v[48:51], v[16:19], v[96:111]
    s_waitcnt lgkmcnt(2)
    v_mfma_f32_32x32x16_bf16 v[96:111], v[52:55], v[20:23], v[96:111]
    s_waitcnt lgkmcnt(1)
    v_mfma_f32_32x32x16_bf16 v[96:111], v[56:59], v[24:27], v[96:111]
    s_waitcnt lgkmcnt(0)
    v_mfma_f32_32x32x16_bf16 v[96:111], v[60:63], v[28:31], v[96:111]
    s_lshl_b32 s23, s21, 13
    v_add_u32 v8, s23, v5
    s_add_u32 s21, s21, 1
    s_and_b32 s21, s21, 3
    s_barrier

    ds_read_b128 v[16:19], v8 offset:0
    ds_read_b128 v[20:23], v8 offset:1024
    ds_read_b128 v[24:27], v8 offset:2048
    ds_read_b128 v[28:31], v8 offset:3072
    s_waitcnt vmcnt(0)
    v_lshlrev_b32 v48, 16, v112
    v_and_b32 v49, s30, v112
    v_lshlrev_b32 v50, 16, v113
    v_and_b32 v51, s30, v113
    v_lshlrev_b32 v52, 16, v114
    v_and_b32 v53, s30, v114
    v_lshlrev_b32 v54, 16, v115
    v_and_b32 v55, s30, v115
    v_lshlrev_b32 v56, 16, v116
    v_and_b32 v57, s30, v116
    v_lshlrev_b32 v58, 16, v117
    v_and_b32 v59, s30, v117
    v_lshlrev_b32 v60, 16, v118
    v_and_b32 v61, s30, v118
    v_lshlrev_b32 v62, 16, v119
    v_and_b32 v63, s30, v119
    s_waitcnt lgkmcnt(3)
    v_mfma_f32_32x32x16_bf16 v[96:111], v[64:67], v[16:19], v[96:111]
    s_waitcnt lgkmcnt(2)
    v_mfma_f32_32x32x16_bf16 v[96:111], v[68:71], v[20:23], v[96:111]
    s_waitcnt lgkmcnt(1)
    v_mfma_f32_32x32x16_bf16 v[96:111], v[72:75], v[24:27], v[96:111]
    s_waitcnt lgkmcnt(0)
    v_mfma_f32_32x32x16_bf16 v[96:111], v[76:79], v[28:31], v[96:111]
    s_lshl_b32 s23, s21, 13
    v_add_u32 v8, s23, v5
    s_add_u32 s21, s21, 1
    s_and_b32 s21, s21, 3
    s_barrier

    ds_read_b128 v[16:19], v8 offset:0
    ds_read_b128 v[20:23], v8 offset:1024
    ds_read_b128 v[24:27], v8 offset:2048
    ds_read_b128 v[28:31], v8 offset:3072
    s_waitcnt lgkmcnt(3)
    v_mfma_f32_32x32x16_bf16 v[96:111], v[80:83], v[16:19], v[96:111]
    s_waitcnt lgkmcnt(2)
    v_mfma_f32_32x32x16_bf16 v[96:111], v[84:87], v[20:23], v[96:111]
    s_waitcnt lgkmcnt(1)
    v_mfma_f32_32x32x16_bf16 v[96:111], v[88:91], v[24:27], v[96:111]
    s_waitcnt lgkmcnt(0)
    v_mfma_f32_32x32x16_bf16 v[96:111], v[92:95], v[28:31], v[96:111]
    s_and_b32 s23, s16, 3
    s_lshl_b32 s23, s23, 12
    v_lshl_add_u32 v8, v1, 4, s23
    s_cmp_eq_u32 s29, 0
    s_cbranch_scc1 L_p3_grp0
    s_nop 7

    ds_write_b128 v8, v[96:99] offset:0
    ds_write_b128 v8, v[100:103] offset:1024
    ds_write_b128 v8, v[104:107] offset:2048
    ds_write_b128 v8, v[108:111] offset:3072
    s_waitcnt lgkmcnt(0)
    s_barrier
    s_endpgm
L_p3_grp0:
    s_nop 0
    s_barrier
    ds_read_b128 v[16:19], v8 offset:0
    ds_read_b128 v[20:23], v8 offset:1024
    ds_read_b128 v[24:27], v8 offset:2048
    ds_read_b128 v[28:31], v8 offset:3072
    s_waitcnt lgkmcnt(3)
    v_pk_add_f32 v[96:97], v[96:97], v[16:17]
    v_pk_add_f32 v[98:99], v[98:99], v[18:19]
    s_waitcnt lgkmcnt(2)
    v_pk_add_f32 v[100:101], v[100:101], v[20:21]
    v_pk_add_f32 v[102:103], v[102:103], v[22:23]
    s_waitcnt lgkmcnt(1)
    v_pk_add_f32 v[104:105], v[104:105], v[24:25]
    v_pk_add_f32 v[106:107], v[106:107], v[26:27]
    s_waitcnt lgkmcnt(0)
    v_pk_add_f32 v[108:109], v[108:109], v[28:29]
    v_pk_add_f32 v[110:111], v[110:111], v[30:31]
    v_pk_add_f32 v[24:25], v[96:97], v[98:99]
    v_pk_mul_f32 v[26:27], v[96:97], v[96:97]
    v_pk_mul_f32 v[28:29], v[96:97], v[48:49]
    v_pk_fma_f32 v[26:27], v[98:99], v[98:99], v[26:27]
    v_pk_fma_f32 v[28:29], v[98:99], v[50:51], v[28:29]

    v_pk_add_f32 v[24:25], v[24:25], v[100:101]
    v_pk_fma_f32 v[26:27], v[100:101], v[100:101], v[26:27]
    v_pk_fma_f32 v[28:29], v[100:101], v[52:53], v[28:29]

    v_pk_add_f32 v[24:25], v[24:25], v[102:103]
    v_pk_fma_f32 v[26:27], v[102:103], v[102:103], v[26:27]
    v_pk_fma_f32 v[28:29], v[102:103], v[54:55], v[28:29]

    v_pk_add_f32 v[24:25], v[24:25], v[104:105]
    v_pk_fma_f32 v[26:27], v[104:105], v[104:105], v[26:27]
    v_pk_fma_f32 v[28:29], v[104:105], v[56:57], v[28:29]

    v_pk_add_f32 v[24:25], v[24:25], v[106:107]
    v_pk_fma_f32 v[26:27], v[106:107], v[106:107], v[26:27]
    v_pk_fma_f32 v[28:29], v[106:107], v[58:59], v[28:29]

    v_pk_add_f32 v[24:25], v[24:25], v[108:109]
    v_pk_fma_f32 v[26:27], v[108:109], v[108:109], v[26:27]
    v_pk_fma_f32 v[28:29], v[108:109], v[60:61], v[28:29]

    v_pk_add_f32 v[24:25], v[24:25], v[110:111]
    v_pk_fma_f32 v[26:27], v[110:111], v[110:111], v[26:27]
    v_pk_fma_f32 v[28:29], v[110:111], v[62:63], v[28:29]

    v_add_f32 v16, v24, v25
    v_add_f32 v17, v26, v27
    v_add_f32 v18, v28, v29

    v_mov_b32 v20, v16
    v_mov_b32 v21, v17
    v_mov_b32 v22, v18
    s_lshl_b32 s23, s18, 10
    s_lshl_b32 s24, s17, 9
    s_add_u32 s23, s23, s24
    s_add_u32 s23, s23, 57600
    v_permlane32_swap_b32 v16, v20
    v_permlane32_swap_b32 v17, v21
    v_permlane32_swap_b32 v18, v22
    v_lshl_add_u32 v4, v3, 4, s23
    v_add_f32 v16, v16, v20
    v_add_f32 v17, v17, v21
    v_add_f32 v18, v18, v22
    ds_write_b128 v4, v[16:19]
    s_lshl_b32 s23, s17, 8
    s_add_u32 s23, s23, 59648
    v_lshl_add_u32 v4, v3, 3, s23
    v_mov_b32 v5, 60160
    v_lshlrev_b32 v7, 10, v3
    v_lshl_add_u32 v7, v2, 4, v7
    s_lshl_b32 s26, s19, 16
    s_lshl_b32 s24, s17, 15
    s_add_u32 s26, s26, s24
    s_lshl_b32 s24, s20, 7
    s_lshl_b32 s25, s18, 6
    s_add_u32 s24, s24, s25
    s_add_u32 s26, s26, s24
    s_lshl_b32 s27, s19, 11
    s_add_u32 s27, s27, 8650752
    s_add_u32 s27, s27, s24
    v_lshlrev_b32 v6, 4, v2
    s_waitcnt lgkmcnt(0)

    s_barrier

    v_cvt_pk_bf16_f32 v80, v96, v97
    v_cvt_pk_bf16_f32 v81, v98, v99
    v_cvt_pk_bf16_f32 v82, v100, v101
    v_cvt_pk_bf16_f32 v83, v102, v103
    v_cvt_pk_bf16_f32 v84, v104, v105
    v_cvt_pk_bf16_f32 v85, v106, v107
    v_cvt_pk_bf16_f32 v86, v108, v109
    v_cvt_pk_bf16_f32 v87, v110, v111
    v_min_u32 v80, 0xfffffffe, v80
    v_min_u32 v81, 0xfffffffe, v81
    v_min_u32 v82, 0xfffffffe, v82
    v_min_u32 v83, 0xfffffffe, v83
    v_min_u32 v84, 0xfffffffe, v84
    v_min_u32 v85, 0xfffffffe, v85
    v_min_u32 v86, 0xfffffffe, v86
    v_min_u32 v87, 0xfffffffe, v87
    s_nop 1
    v_permlane32_swap_b32 v80, v82
    v_permlane32_swap_b32 v81, v83
    v_permlane32_swap_b32 v84, v86
    v_permlane32_swap_b32 v85, v87
    s_barrier
    ds_read_b64 v[16:17], v4
    ds_read_b32 v18, v5

    s_waitcnt lgkmcnt(0)
    v_readfirstlane_b32 s28, v18
    v_add_f32 v20, 1.0, v16
    s_lshr_b32 s29, s28, 5
    s_and_b32 s28, s28, 31
    s_lshl_b32 s52, 1, s28
    s_mov_b32 s53, s52
    s_cmp_lg_u32 s29, s17
    s_cbranch_scc1 L_p3_nocand

    v_fma_f32 v48, v96, v16, v17
    v_fma_f32 v49, v97, v16, v17
    v_fma_f32 v50, v98, v16, v17
    v_fma_f32 v51, v99, v16, v17
    v_fma_f32 v52, v100, v16, v17
    v_fma_f32 v53, v101, v16, v17
    v_fma_f32 v54, v102, v16, v17
    v_fma_f32 v55, v103, v16, v17
    v_fma_f32 v56, v104, v16, v17
    v_fma_f32 v57, v105, v16, v17
    v_fma_f32 v58, v106, v16, v17
    v_fma_f32 v59, v107, v16, v17
    v_fma_f32 v60, v108, v16, v17
    v_fma_f32 v61, v109, v16, v17
    v_fma_f32 v62, v110, v16, v17
    v_fma_f32 v63, v111, v16, v17
    v_cvt_pk_bf16_f32 v24, v48, v49
    v_cvt_pk_bf16_f32 v25, v50, v51
    v_cvt_pk_bf16_f32 v26, v52, v53
    v_cvt_pk_bf16_f32 v27, v54, v55
    v_cvt_pk_bf16_f32 v28, v56, v57
    v_cvt_pk_bf16_f32 v29, v58, v59
    v_cvt_pk_bf16_f32 v30, v60, v61
    v_cvt_pk_bf16_f32 v31, v62, v63
    v_min_u32 v24, 0xfffffffe, v24
    v_min_u32 v25, 0xfffffffe, v25
    v_min_u32 v26, 0xfffffffe, v26
    v_min_u32 v27, 0xfffffffe, v27
    v_min_u32 v28, 0xfffffffe, v28
    v_min_u32 v29, 0xfffffffe, v29
    v_min_u32 v30, 0xfffffffe, v30
    v_min_u32 v31, 0xfffffffe, v31
    s_nop 1
    v_permlane32_swap_b32 v24, v26
    v_permlane32_swap_b32 v25, v27
    v_permlane32_swap_b32 v28, v30
    v_permlane32_swap_b32 v29, v31

    s_mov_b64 exec, s[52:53]
    buffer_store_dwordx4 v[24:27], v6, s[12:15], s27 offen sc1
    buffer_store_dwordx4 v[28:31], v6, s[12:15], s27 offen offset:32 sc1
    s_mov_b64 exec, -1

L_p3_nocand:
    v_fma_f32 v48, v96, v20, v17
    v_fma_f32 v49, v97, v20, v17
    v_fma_f32 v50, v98, v20, v17
    v_fma_f32 v51, v99, v20, v17
    v_fma_f32 v52, v100, v20, v17
    v_fma_f32 v53, v101, v20, v17
    v_fma_f32 v54, v102, v20, v17
    v_fma_f32 v55, v103, v20, v17
    v_fma_f32 v56, v104, v20, v17
    v_fma_f32 v57, v105, v20, v17
    v_fma_f32 v58, v106, v20, v17
    v_fma_f32 v59, v107, v20, v17
    v_fma_f32 v60, v108, v20, v17
    v_fma_f32 v61, v109, v20, v17
    v_fma_f32 v62, v110, v20, v17
    v_fma_f32 v63, v111, v20, v17
    v_cvt_pk_bf16_f32 v32, v48, v49
    v_cvt_pk_bf16_f32 v33, v50, v51
    v_cvt_pk_bf16_f32 v34, v52, v53
    v_cvt_pk_bf16_f32 v35, v54, v55
    v_cvt_pk_bf16_f32 v36, v56, v57
    v_cvt_pk_bf16_f32 v37, v58, v59
    v_cvt_pk_bf16_f32 v38, v60, v61
    v_cvt_pk_bf16_f32 v39, v62, v63
    s_nop 1
    v_permlane32_swap_b32 v32, v34
    v_permlane32_swap_b32 v33, v35
    v_permlane32_swap_b32 v36, v38
    v_permlane32_swap_b32 v37, v39

    s_cmp_lg_u32 s29, s17
    s_cbranch_scc1 L_p3_plain
    s_mov_b64 exec, s[52:53]
    buffer_store_dwordx4 v[32:35], v7, s[32:35], s26 offen sc1
    buffer_store_dwordx4 v[36:39], v7, s[32:35], s26 offen offset:32 sc1
    s_waitcnt vmcnt(0)
    buffer_store_dwordx4 v[80:83], v6, s[12:15], s27 offen offset:1024 sc1
    buffer_store_dwordx4 v[84:87], v6, s[12:15], s27 offen offset:1056 sc1
    s_not_b64 exec, s[52:53]

L_p3_plain:
    buffer_store_dwordx4 v[32:35], v7, s[32:35], s26 offen
    buffer_store_dwordx4 v[36:39], v7, s[32:35], s26 offen offset:32

    s_endpgm
L_end:
    s_endpgm
.p2align 10
L_code_end:
    s_endpgm
.section .rodata,"a"
.p2align 6
.amdhsa_kernel sequential_preLN__mha_block__moe_arch_mod__prompt_kernel
  .amdhsa_next_free_vgpr 128
  .amdhsa_next_free_sgpr 102
  .amdhsa_accum_offset 128
  .amdhsa_group_segment_fixed_size 0
  .amdhsa_kernarg_size 88
  .amdhsa_user_sgpr_count 2
  .amdhsa_user_sgpr_kernarg_segment_ptr 1
  .amdhsa_system_sgpr_workgroup_id_x 1
.end_amdhsa_kernel
```
